```python
import torch

def _softmax(x, axis=-1):
    return torch.softmax(x, dim=axis)

def _gelu(x):
    return torch.nn.functional.gelu(x, approximate='tanh')

def _silu(x):
    return torch.nn.functional.silu(x)

def _sigmoid(x):
    return torch.sigmoid(x)

def _layernorm(x, axis=-1, eps=1e-05):
    m = x.mean(dim=axis, keepdim=True)
    v = x.var(dim=axis, keepdim=True, unbiased=False)
    return (x - m) / torch.sqrt(v + eps)

def _scatter_add(tgt, idx, src, axis=0):
    return tgt.clone().index_add_(axis, idx, src)

def _segment_sum(src, seg, n):
    out = torch.zeros((n,) + src.shape[1:], dtype=src.dtype)
    return out.index_add_(0, seg, src)

def _pad(x, pw):
    flat = tuple((v for pair in reversed(pw) for v in pair))
    return torch.nn.functional.pad(x, flat)
kernel_name = 'standalone__window_attn_twins__vision'

def setup_inputs():

    _w = lambda a: (lambda t: t.to(torch.bfloat16) if t.is_floating_point() else t)(torch.as_tensor(a))
    H = W = 384 // 8 * 8
    C = 96
    return {'x': _w((lambda *s: torch.randn(*s, dtype=torch.bfloat16) * 0.8)(1, H, W, C)), 'wq': _w((lambda *s: torch.randn(*s, dtype=torch.bfloat16) * 0.8)(C, C)), 'wkv': _w((lambda *s: torch.randn(*s, dtype=torch.bfloat16) * 0.8)(C, 2 * C)), 'wo': _w((lambda *s: torch.randn(*s, dtype=torch.bfloat16) * 0.05)(C, C))}

def reference(x, wq, wkv, wo):
    B, H, W, C = x.shape
    win = 8
    nh, nw = (H // win, W // win)
    xs = x.reshape(B, nh, win, nw, win, C).mean(axis=(2, 4)).reshape(B, nh * nw, C)
    q = x.reshape(B, H * W, C) @ wq
    kv = xs @ wkv
    k, v = (kv[..., :C].clone(), kv[..., C:].clone())
    scale = C ** (-0.5)
    p = _softmax(torch.einsum('bqc,bkc->bqk', q, k) * scale, axis=-1)
    o = torch.einsum('bqk,bkc->bqc', p, v) @ wo
    return o.reshape(B, H, W, C)
```

```asm
; @launch kernel=prep_means_kernel grid=(315,1,1) block=(256,1,1) lds=24576
; @launch kernel=prep_kv_kernel grid=(72,1,1) block=(192,1,1) lds=19456
; @launch kernel=attn_main_kernel grid=(256,1,1) block=(768,1,1) lds=147456
.amdgcn_target "amdgcn-amd-amdhsa--gfx950"
.text
.globl prep_means_kernel
.p2align 8
.type prep_means_kernel,@function
prep_means_kernel:
    s_cmp_ge_u32 s2, 315
    s_cbranch_scc1 L_p1_end
    s_load_dwordx2 s[4:5], s[0:1], 0
    s_load_dwordx2 s[6:7], s[0:1], 16
    s_load_dwordx2 s[20:21], s[0:1], 24
    s_load_dwordx2 s[22:23], s[0:1], 48
    s_waitcnt lgkmcnt(0)
    s_mov_b32 s8, s4
    s_and_b32 s9, s5, 0xffff
    s_mov_b32 s10, 0x1b00000
    s_mov_b32 s11, 0x00020000
    s_mov_b32 s12, s22
    s_and_b32 s13, s23, 0xffff
    s_mov_b32 s14, 0x10000000
    s_mov_b32 s15, 0x00020000
    s_mov_b32 s16, s6
    s_and_b32 s17, s7, 0xffff
    s_mov_b32 s18, 0x9000
    s_mov_b32 s19, 0x00020000
    s_mov_b32 s24, s20
    s_and_b32 s25, s21, 0xffff
    s_mov_b32 s26, 0x4800
    s_mov_b32 s27, 0x00020000
    s_cmp_ge_u32 s2, 288
    s_cbranch_scc1 L_p1_tr
    v_lshrrev_b32 v1, 6, v0
    v_and_b32 v2, 63, v0
    s_nop 0
    v_readfirstlane_b32 s28, v1
    s_lshl_b32 s29, s2, 2
    s_add_u32 s29, s29, s28
    s_mul_i32 s30, s29, 43691
    s_lshr_b32 s30, s30, 20
    s_mul_i32 s31, s30, 24
    s_sub_u32 s31, s29, s31
    s_mul_i32 s32, s30, 589824
    s_mul_i32 s33, s31, 3072
    s_add_u32 s32, s32, s33
    v_lshlrev_b32 v3, 4, v2
    buffer_load_dwordx4 v[8:11], v3, s[8:11], s32 offen offset:0
    buffer_load_dwordx4 v[12:15], v3, s[8:11], s32 offen offset:1024
    buffer_load_dwordx4 v[16:19], v3, s[8:11], s32 offen offset:2048
    s_add_u32 s33, s32, 73728
    buffer_load_dwordx4 v[20:23], v3, s[8:11], s33 offen offset:0
    buffer_load_dwordx4 v[24:27], v3, s[8:11], s33 offen offset:1024
    buffer_load_dwordx4 v[28:31], v3, s[8:11], s33 offen offset:2048
    s_add_u32 s33, s33, 73728
    buffer_load_dwordx4 v[32:35], v3, s[8:11], s33 offen offset:0
    buffer_load_dwordx4 v[36:39], v3, s[8:11], s33 offen offset:1024
    buffer_load_dwordx4 v[40:43], v3, s[8:11], s33 offen offset:2048
    s_add_u32 s33, s33, 73728
    buffer_load_dwordx4 v[44:47], v3, s[8:11], s33 offen offset:0
    buffer_load_dwordx4 v[48:51], v3, s[8:11], s33 offen offset:1024
    buffer_load_dwordx4 v[52:55], v3, s[8:11], s33 offen offset:2048
    s_add_u32 s33, s33, 73728
    buffer_load_dwordx4 v[56:59], v3, s[8:11], s33 offen offset:0
    buffer_load_dwordx4 v[60:63], v3, s[8:11], s33 offen offset:1024
    buffer_load_dwordx4 v[64:67], v3, s[8:11], s33 offen offset:2048
    s_add_u32 s33, s33, 73728
    buffer_load_dwordx4 v[68:71], v3, s[8:11], s33 offen offset:0
    buffer_load_dwordx4 v[72:75], v3, s[8:11], s33 offen offset:1024
    buffer_load_dwordx4 v[76:79], v3, s[8:11], s33 offen offset:2048
    s_add_u32 s33, s33, 73728
    buffer_load_dwordx4 v[80:83], v3, s[8:11], s33 offen offset:0
    buffer_load_dwordx4 v[84:87], v3, s[8:11], s33 offen offset:1024
    buffer_load_dwordx4 v[88:91], v3, s[8:11], s33 offen offset:2048
    s_add_u32 s33, s33, 73728
    buffer_load_dwordx4 v[92:95], v3, s[8:11], s33 offen offset:0
    buffer_load_dwordx4 v[96:99], v3, s[8:11], s33 offen offset:1024
    buffer_load_dwordx4 v[100:103], v3, s[8:11], s33 offen offset:2048
    s_waitcnt vmcnt(23)
    v_lshlrev_b32 v104, 16, v8
    v_and_b32 v105, 0xffff0000, v8
    v_lshlrev_b32 v106, 16, v9
    v_and_b32 v107, 0xffff0000, v9
    v_lshlrev_b32 v108, 16, v10
    v_and_b32 v109, 0xffff0000, v10
    v_lshlrev_b32 v110, 16, v11
    v_and_b32 v111, 0xffff0000, v11
    s_waitcnt vmcnt(22)
    v_lshlrev_b32 v112, 16, v12
    v_and_b32 v113, 0xffff0000, v12
    v_lshlrev_b32 v114, 16, v13
    v_and_b32 v115, 0xffff0000, v13
    v_lshlrev_b32 v116, 16, v14
    v_and_b32 v117, 0xffff0000, v14
    v_lshlrev_b32 v118, 16, v15
    v_and_b32 v119, 0xffff0000, v15
    s_waitcnt vmcnt(21)
    v_lshlrev_b32 v120, 16, v16
    v_and_b32 v121, 0xffff0000, v16
    v_lshlrev_b32 v122, 16, v17
    v_and_b32 v123, 0xffff0000, v17
    v_lshlrev_b32 v124, 16, v18
    v_and_b32 v125, 0xffff0000, v18
    v_lshlrev_b32 v126, 16, v19
    v_and_b32 v127, 0xffff0000, v19
    s_waitcnt vmcnt(20)
    v_lshlrev_b32 v4, 16, v20
    v_and_b32 v5, 0xffff0000, v20
    v_add_f32 v104, v104, v4
    v_add_f32 v105, v105, v5
    v_lshlrev_b32 v4, 16, v21
    v_and_b32 v5, 0xffff0000, v21
    v_add_f32 v106, v106, v4
    v_add_f32 v107, v107, v5
    v_lshlrev_b32 v4, 16, v22
    v_and_b32 v5, 0xffff0000, v22
    v_add_f32 v108, v108, v4
    v_add_f32 v109, v109, v5
    v_lshlrev_b32 v4, 16, v23
    v_and_b32 v5, 0xffff0000, v23
    v_add_f32 v110, v110, v4
    v_add_f32 v111, v111, v5
    s_waitcnt vmcnt(19)
    v_lshlrev_b32 v4, 16, v24
    v_and_b32 v5, 0xffff0000, v24
    v_add_f32 v112, v112, v4
    v_add_f32 v113, v113, v5
    v_lshlrev_b32 v4, 16, v25
    v_and_b32 v5, 0xffff0000, v25
    v_add_f32 v114, v114, v4
    v_add_f32 v115, v115, v5
    v_lshlrev_b32 v4, 16, v26
    v_and_b32 v5, 0xffff0000, v26
    v_add_f32 v116, v116, v4
    v_add_f32 v117, v117, v5
    v_lshlrev_b32 v4, 16, v27
    v_and_b32 v5, 0xffff0000, v27
    v_add_f32 v118, v118, v4
    v_add_f32 v119, v119, v5
    s_waitcnt vmcnt(18)
    v_lshlrev_b32 v4, 16, v28
    v_and_b32 v5, 0xffff0000, v28
    v_add_f32 v120, v120, v4
    v_add_f32 v121, v121, v5
    v_lshlrev_b32 v4, 16, v29
    v_and_b32 v5, 0xffff0000, v29
    v_add_f32 v122, v122, v4
    v_add_f32 v123, v123, v5
    v_lshlrev_b32 v4, 16, v30
    v_and_b32 v5, 0xffff0000, v30
    v_add_f32 v124, v124, v4
    v_add_f32 v125, v125, v5
    v_lshlrev_b32 v4, 16, v31
    v_and_b32 v5, 0xffff0000, v31
    v_add_f32 v126, v126, v4
    v_add_f32 v127, v127, v5
    s_waitcnt vmcnt(17)
    v_lshlrev_b32 v4, 16, v32
    v_and_b32 v5, 0xffff0000, v32
    v_add_f32 v104, v104, v4
    v_add_f32 v105, v105, v5
    v_lshlrev_b32 v4, 16, v33
    v_and_b32 v5, 0xffff0000, v33
    v_add_f32 v106, v106, v4
    v_add_f32 v107, v107, v5
    v_lshlrev_b32 v4, 16, v34
    v_and_b32 v5, 0xffff0000, v34
    v_add_f32 v108, v108, v4
    v_add_f32 v109, v109, v5
    v_lshlrev_b32 v4, 16, v35
    v_and_b32 v5, 0xffff0000, v35
    v_add_f32 v110, v110, v4
    v_add_f32 v111, v111, v5
    s_waitcnt vmcnt(16)
    v_lshlrev_b32 v4, 16, v36
    v_and_b32 v5, 0xffff0000, v36
    v_add_f32 v112, v112, v4
    v_add_f32 v113, v113, v5
    v_lshlrev_b32 v4, 16, v37
    v_and_b32 v5, 0xffff0000, v37
    v_add_f32 v114, v114, v4
    v_add_f32 v115, v115, v5
    v_lshlrev_b32 v4, 16, v38
    v_and_b32 v5, 0xffff0000, v38
    v_add_f32 v116, v116, v4
    v_add_f32 v117, v117, v5
    v_lshlrev_b32 v4, 16, v39
    v_and_b32 v5, 0xffff0000, v39
    v_add_f32 v118, v118, v4
    v_add_f32 v119, v119, v5
    s_waitcnt vmcnt(15)
    v_lshlrev_b32 v4, 16, v40
    v_and_b32 v5, 0xffff0000, v40
    v_add_f32 v120, v120, v4
    v_add_f32 v121, v121, v5
    v_lshlrev_b32 v4, 16, v41
    v_and_b32 v5, 0xffff0000, v41
    v_add_f32 v122, v122, v4
    v_add_f32 v123, v123, v5
    v_lshlrev_b32 v4, 16, v42
    v_and_b32 v5, 0xffff0000, v42
    v_add_f32 v124, v124, v4
    v_add_f32 v125, v125, v5
    v_lshlrev_b32 v4, 16, v43
    v_and_b32 v5, 0xffff0000, v43
    v_add_f32 v126, v126, v4
    v_add_f32 v127, v127, v5
    s_waitcnt vmcnt(14)
    v_lshlrev_b32 v4, 16, v44
    v_and_b32 v5, 0xffff0000, v44
    v_add_f32 v104, v104, v4
    v_add_f32 v105, v105, v5
    v_lshlrev_b32 v4, 16, v45
    v_and_b32 v5, 0xffff0000, v45
    v_add_f32 v106, v106, v4
    v_add_f32 v107, v107, v5
    v_lshlrev_b32 v4, 16, v46
    v_and_b32 v5, 0xffff0000, v46
    v_add_f32 v108, v108, v4
    v_add_f32 v109, v109, v5
    v_lshlrev_b32 v4, 16, v47
    v_and_b32 v5, 0xffff0000, v47
    v_add_f32 v110, v110, v4
    v_add_f32 v111, v111, v5
    s_waitcnt vmcnt(13)
    v_lshlrev_b32 v4, 16, v48
    v_and_b32 v5, 0xffff0000, v48
    v_add_f32 v112, v112, v4
    v_add_f32 v113, v113, v5
    v_lshlrev_b32 v4, 16, v49
    v_and_b32 v5, 0xffff0000, v49
    v_add_f32 v114, v114, v4
    v_add_f32 v115, v115, v5
    v_lshlrev_b32 v4, 16, v50
    v_and_b32 v5, 0xffff0000, v50
    v_add_f32 v116, v116, v4
    v_add_f32 v117, v117, v5
    v_lshlrev_b32 v4, 16, v51
    v_and_b32 v5, 0xffff0000, v51
    v_add_f32 v118, v118, v4
    v_add_f32 v119, v119, v5
    s_waitcnt vmcnt(12)
    v_lshlrev_b32 v4, 16, v52
    v_and_b32 v5, 0xffff0000, v52
    v_add_f32 v120, v120, v4
    v_add_f32 v121, v121, v5
    v_lshlrev_b32 v4, 16, v53
    v_and_b32 v5, 0xffff0000, v53
    v_add_f32 v122, v122, v4
    v_add_f32 v123, v123, v5
    v_lshlrev_b32 v4, 16, v54
    v_and_b32 v5, 0xffff0000, v54
    v_add_f32 v124, v124, v4
    v_add_f32 v125, v125, v5
    v_lshlrev_b32 v4, 16, v55
    v_and_b32 v5, 0xffff0000, v55
    v_add_f32 v126, v126, v4
    v_add_f32 v127, v127, v5
    s_waitcnt vmcnt(11)
    v_lshlrev_b32 v4, 16, v56
    v_and_b32 v5, 0xffff0000, v56
    v_add_f32 v104, v104, v4
    v_add_f32 v105, v105, v5
    v_lshlrev_b32 v4, 16, v57
    v_and_b32 v5, 0xffff0000, v57
    v_add_f32 v106, v106, v4
    v_add_f32 v107, v107, v5
    v_lshlrev_b32 v4, 16, v58
    v_and_b32 v5, 0xffff0000, v58
    v_add_f32 v108, v108, v4
    v_add_f32 v109, v109, v5
    v_lshlrev_b32 v4, 16, v59
    v_and_b32 v5, 0xffff0000, v59
    v_add_f32 v110, v110, v4
    v_add_f32 v111, v111, v5
    s_waitcnt vmcnt(10)
    v_lshlrev_b32 v4, 16, v60
    v_and_b32 v5, 0xffff0000, v60
    v_add_f32 v112, v112, v4
    v_add_f32 v113, v113, v5
    v_lshlrev_b32 v4, 16, v61
    v_and_b32 v5, 0xffff0000, v61
    v_add_f32 v114, v114, v4
    v_add_f32 v115, v115, v5
    v_lshlrev_b32 v4, 16, v62
    v_and_b32 v5, 0xffff0000, v62
    v_add_f32 v116, v116, v4
    v_add_f32 v117, v117, v5
    v_lshlrev_b32 v4, 16, v63
    v_and_b32 v5, 0xffff0000, v63
    v_add_f32 v118, v118, v4
    v_add_f32 v119, v119, v5
    s_waitcnt vmcnt(9)
    v_lshlrev_b32 v4, 16, v64
    v_and_b32 v5, 0xffff0000, v64
    v_add_f32 v120, v120, v4
    v_add_f32 v121, v121, v5
    v_lshlrev_b32 v4, 16, v65
    v_and_b32 v5, 0xffff0000, v65
    v_add_f32 v122, v122, v4
    v_add_f32 v123, v123, v5
    v_lshlrev_b32 v4, 16, v66
    v_and_b32 v5, 0xffff0000, v66
    v_add_f32 v124, v124, v4
    v_add_f32 v125, v125, v5
    v_lshlrev_b32 v4, 16, v67
    v_and_b32 v5, 0xffff0000, v67
    v_add_f32 v126, v126, v4
    v_add_f32 v127, v127, v5
    s_waitcnt vmcnt(8)
    v_lshlrev_b32 v4, 16, v68
    v_and_b32 v5, 0xffff0000, v68
    v_add_f32 v104, v104, v4
    v_add_f32 v105, v105, v5
    v_lshlrev_b32 v4, 16, v69
    v_and_b32 v5, 0xffff0000, v69
    v_add_f32 v106, v106, v4
    v_add_f32 v107, v107, v5
    v_lshlrev_b32 v4, 16, v70
    v_and_b32 v5, 0xffff0000, v70
    v_add_f32 v108, v108, v4
    v_add_f32 v109, v109, v5
    v_lshlrev_b32 v4, 16, v71
    v_and_b32 v5, 0xffff0000, v71
    v_add_f32 v110, v110, v4
    v_add_f32 v111, v111, v5
    s_waitcnt vmcnt(7)
    v_lshlrev_b32 v4, 16, v72
    v_and_b32 v5, 0xffff0000, v72
    v_add_f32 v112, v112, v4
    v_add_f32 v113, v113, v5
    v_lshlrev_b32 v4, 16, v73
    v_and_b32 v5, 0xffff0000, v73
    v_add_f32 v114, v114, v4
    v_add_f32 v115, v115, v5
    v_lshlrev_b32 v4, 16, v74
    v_and_b32 v5, 0xffff0000, v74
    v_add_f32 v116, v116, v4
    v_add_f32 v117, v117, v5
    v_lshlrev_b32 v4, 16, v75
    v_and_b32 v5, 0xffff0000, v75
    v_add_f32 v118, v118, v4
    v_add_f32 v119, v119, v5
    s_waitcnt vmcnt(6)
    v_lshlrev_b32 v4, 16, v76
    v_and_b32 v5, 0xffff0000, v76
    v_add_f32 v120, v120, v4
    v_add_f32 v121, v121, v5
    v_lshlrev_b32 v4, 16, v77
    v_and_b32 v5, 0xffff0000, v77
    v_add_f32 v122, v122, v4
    v_add_f32 v123, v123, v5
    v_lshlrev_b32 v4, 16, v78
    v_and_b32 v5, 0xffff0000, v78
    v_add_f32 v124, v124, v4
    v_add_f32 v125, v125, v5
    v_lshlrev_b32 v4, 16, v79
    v_and_b32 v5, 0xffff0000, v79
    v_add_f32 v126, v126, v4
    v_add_f32 v127, v127, v5
    s_waitcnt vmcnt(5)
    v_lshlrev_b32 v4, 16, v80
    v_and_b32 v5, 0xffff0000, v80
    v_add_f32 v104, v104, v4
    v_add_f32 v105, v105, v5
    v_lshlrev_b32 v4, 16, v81
    v_and_b32 v5, 0xffff0000, v81
    v_add_f32 v106, v106, v4
    v_add_f32 v107, v107, v5
    v_lshlrev_b32 v4, 16, v82
    v_and_b32 v5, 0xffff0000, v82
    v_add_f32 v108, v108, v4
    v_add_f32 v109, v109, v5
    v_lshlrev_b32 v4, 16, v83
    v_and_b32 v5, 0xffff0000, v83
    v_add_f32 v110, v110, v4
    v_add_f32 v111, v111, v5
    s_waitcnt vmcnt(4)
    v_lshlrev_b32 v4, 16, v84
    v_and_b32 v5, 0xffff0000, v84
    v_add_f32 v112, v112, v4
    v_add_f32 v113, v113, v5
    v_lshlrev_b32 v4, 16, v85
    v_and_b32 v5, 0xffff0000, v85
    v_add_f32 v114, v114, v4
    v_add_f32 v115, v115, v5
    v_lshlrev_b32 v4, 16, v86
    v_and_b32 v5, 0xffff0000, v86
    v_add_f32 v116, v116, v4
    v_add_f32 v117, v117, v5
    v_lshlrev_b32 v4, 16, v87
    v_and_b32 v5, 0xffff0000, v87
    v_add_f32 v118, v118, v4
    v_add_f32 v119, v119, v5
    s_waitcnt vmcnt(3)
    v_lshlrev_b32 v4, 16, v88
    v_and_b32 v5, 0xffff0000, v88
    v_add_f32 v120, v120, v4
    v_add_f32 v121, v121, v5
    v_lshlrev_b32 v4, 16, v89
    v_and_b32 v5, 0xffff0000, v89
    v_add_f32 v122, v122, v4
    v_add_f32 v123, v123, v5
    v_lshlrev_b32 v4, 16, v90
    v_and_b32 v5, 0xffff0000, v90
    v_add_f32 v124, v124, v4
    v_add_f32 v125, v125, v5
    v_lshlrev_b32 v4, 16, v91
    v_and_b32 v5, 0xffff0000, v91
    v_add_f32 v126, v126, v4
    v_add_f32 v127, v127, v5
    s_waitcnt vmcnt(2)
    v_lshlrev_b32 v4, 16, v92
    v_and_b32 v5, 0xffff0000, v92
    v_add_f32 v104, v104, v4
    v_add_f32 v105, v105, v5
    v_lshlrev_b32 v4, 16, v93
    v_and_b32 v5, 0xffff0000, v93
    v_add_f32 v106, v106, v4
    v_add_f32 v107, v107, v5
    v_lshlrev_b32 v4, 16, v94
    v_and_b32 v5, 0xffff0000, v94
    v_add_f32 v108, v108, v4
    v_add_f32 v109, v109, v5
    v_lshlrev_b32 v4, 16, v95
    v_and_b32 v5, 0xffff0000, v95
    v_add_f32 v110, v110, v4
    v_add_f32 v111, v111, v5
    s_waitcnt vmcnt(1)
    v_lshlrev_b32 v4, 16, v96
    v_and_b32 v5, 0xffff0000, v96
    v_add_f32 v112, v112, v4
    v_add_f32 v113, v113, v5
    v_lshlrev_b32 v4, 16, v97
    v_and_b32 v5, 0xffff0000, v97
    v_add_f32 v114, v114, v4
    v_add_f32 v115, v115, v5
    v_lshlrev_b32 v4, 16, v98
    v_and_b32 v5, 0xffff0000, v98
    v_add_f32 v116, v116, v4
    v_add_f32 v117, v117, v5
    v_lshlrev_b32 v4, 16, v99
    v_and_b32 v5, 0xffff0000, v99
    v_add_f32 v118, v118, v4
    v_add_f32 v119, v119, v5
    s_waitcnt vmcnt(0)
    v_lshlrev_b32 v4, 16, v100
    v_and_b32 v5, 0xffff0000, v100
    v_add_f32 v120, v120, v4
    v_add_f32 v121, v121, v5
    v_lshlrev_b32 v4, 16, v101
    v_and_b32 v5, 0xffff0000, v101
    v_add_f32 v122, v122, v4
    v_add_f32 v123, v123, v5
    v_lshlrev_b32 v4, 16, v102
    v_and_b32 v5, 0xffff0000, v102
    v_add_f32 v124, v124, v4
    v_add_f32 v125, v125, v5
    v_lshlrev_b32 v4, 16, v103
    v_and_b32 v5, 0xffff0000, v103
    v_add_f32 v126, v126, v4
    v_add_f32 v127, v127, v5
    s_mul_i32 s34, s28, 6144
    v_lshlrev_b32 v4, 5, v2
    v_add_u32 v4, s34, v4
    ds_write_b128 v4, v[104:107] offset:0
    ds_write_b128 v4, v[108:111] offset:16
    ds_write_b128 v4, v[112:115] offset:2048
    ds_write_b128 v4, v[116:119] offset:2064
    ds_write_b128 v4, v[120:123] offset:4096
    ds_write_b128 v4, v[124:127] offset:4112
    s_waitcnt lgkmcnt(0)
    s_mul_i32 s35, s30, 48
    s_lshl_b32 s36, s31, 1
    s_add_u32 s35, s35, s36
    s_mul_i32 s35, s35, 192
    v_mov_b32 v11, 96
    v_add_u32 v5, 0, v2
    v_cmp_le_u32 vcc, 96, v5
    s_nop 1
    v_cndmask_b32 v6, 0, v11, vcc
    v_sub_u32 v7, v5, v6
    v_lshrrev_b32 v8, 3, v7
    v_add_u32 v8, v8, v6
    v_lshlrev_b32 v8, 5, v8
    v_and_b32 v9, 7, v7
    v_lshlrev_b32 v9, 2, v9
    v_add3_u32 v8, v8, v9, s34
    ds_read_b32 v10, v8 offset:0
    ds_read_b32 v11, v8 offset:384
    ds_read_b32 v12, v8 offset:768
    ds_read_b32 v13, v8 offset:1152
    ds_read_b32 v14, v8 offset:1536
    ds_read_b32 v15, v8 offset:1920
    ds_read_b32 v16, v8 offset:2304
    ds_read_b32 v17, v8 offset:2688
    s_waitcnt lgkmcnt(0)
    v_add_f32 v10, v10, v11
    v_add_f32 v10, v10, v12
    v_add_f32 v10, v10, v13
    v_add_f32 v10, v10, v14
    v_add_f32 v10, v10, v15
    v_add_f32 v10, v10, v16
    v_add_f32 v10, v10, v17
    v_mul_f32 v10, 0x3c800000, v10
    v_cvt_pk_bf16_f32 v10, v10, v10
    v_lshlrev_b32 v5, 1, v5
    v_add_u32 v5, s35, v5
    buffer_store_short v10, v5, s[12:15], 0 offen offset:0
    v_mov_b32 v11, 96
    v_add_u32 v5, 64, v2
    v_cmp_le_u32 vcc, 96, v5
    s_nop 1
    v_cndmask_b32 v6, 0, v11, vcc
    v_sub_u32 v7, v5, v6
    v_lshrrev_b32 v8, 3, v7
    v_add_u32 v8, v8, v6
    v_lshlrev_b32 v8, 5, v8
    v_and_b32 v9, 7, v7
    v_lshlrev_b32 v9, 2, v9
    v_add3_u32 v8, v8, v9, s34
    ds_read_b32 v10, v8 offset:0
    ds_read_b32 v11, v8 offset:384
    ds_read_b32 v12, v8 offset:768
    ds_read_b32 v13, v8 offset:1152
    ds_read_b32 v14, v8 offset:1536
    ds_read_b32 v15, v8 offset:1920
    ds_read_b32 v16, v8 offset:2304
    ds_read_b32 v17, v8 offset:2688
    s_waitcnt lgkmcnt(0)
    v_add_f32 v10, v10, v11
    v_add_f32 v10, v10, v12
    v_add_f32 v10, v10, v13
    v_add_f32 v10, v10, v14
    v_add_f32 v10, v10, v15
    v_add_f32 v10, v10, v16
    v_add_f32 v10, v10, v17
    v_mul_f32 v10, 0x3c800000, v10
    v_cvt_pk_bf16_f32 v10, v10, v10
    v_lshlrev_b32 v5, 1, v5
    v_add_u32 v5, s35, v5
    buffer_store_short v10, v5, s[12:15], 0 offen offset:0
    v_mov_b32 v11, 96
    v_add_u32 v5, 128, v2
    v_cmp_le_u32 vcc, 96, v5
    s_nop 1
    v_cndmask_b32 v6, 0, v11, vcc
    v_sub_u32 v7, v5, v6
    v_lshrrev_b32 v8, 3, v7
    v_add_u32 v8, v8, v6
    v_lshlrev_b32 v8, 5, v8
    v_and_b32 v9, 7, v7
    v_lshlrev_b32 v9, 2, v9
    v_add3_u32 v8, v8, v9, s34
    ds_read_b32 v10, v8 offset:0
    ds_read_b32 v11, v8 offset:384
    ds_read_b32 v12, v8 offset:768
    ds_read_b32 v13, v8 offset:1152
    ds_read_b32 v14, v8 offset:1536
    ds_read_b32 v15, v8 offset:1920
    ds_read_b32 v16, v8 offset:2304
    ds_read_b32 v17, v8 offset:2688
    s_waitcnt lgkmcnt(0)
    v_add_f32 v10, v10, v11
    v_add_f32 v10, v10, v12
    v_add_f32 v10, v10, v13
    v_add_f32 v10, v10, v14
    v_add_f32 v10, v10, v15
    v_add_f32 v10, v10, v16
    v_add_f32 v10, v10, v17
    v_mul_f32 v10, 0x3c800000, v10
    v_cvt_pk_bf16_f32 v10, v10, v10
    v_lshlrev_b32 v5, 1, v5
    v_add_u32 v5, s35, v5
    buffer_store_short v10, v5, s[12:15], 0 offen offset:0
    s_branch L_p1_end
L_p1_tr:
    s_sub_u32 s28, s2, 288
    s_lshl_b32 s28, s28, 8
    v_add_u32 v1, s28, v0
    v_lshlrev_b32 v1, 2, v1
    s_cmp_ge_u32 s2, 306
    s_cbranch_scc1 L_p1_tr_wo
    s_mov_b32 s29, 43691
    v_mul_lo_u32 v2, v1, s29
    v_lshrrev_b32 v2, 22, v2
    v_mul_u32_u24 v3, 96, v2
    v_sub_u32 v3, v1, v3
    v_mul_u32_u24 v4, 192, v3
    v_add_u32 v4, v4, v2
    v_lshlrev_b32 v4, 1, v4
    buffer_load_ushort v6, v4, s[16:19], 0 offen offset:0
    buffer_load_ushort v7, v4, s[16:19], 0 offen offset:384
    buffer_load_ushort v8, v4, s[16:19], 0 offen offset:768
    buffer_load_ushort v9, v4, s[16:19], 0 offen offset:1152
    s_waitcnt vmcnt(0)
    v_lshlrev_b32 v7, 16, v7
    v_or_b32 v6, v6, v7
    v_lshlrev_b32 v9, 16, v9
    v_or_b32 v7, v8, v9
    v_lshlrev_b32 v1, 1, v1
    v_add_u32 v1, 0x80000, v1
    buffer_store_dwordx2 v[6:7], v1, s[12:15], 0 offen
    s_branch L_p1_end
L_p1_tr_wo:
    v_subrev_u32 v1, 18432, v1
    s_mov_b32 s29, 43691
    v_mul_lo_u32 v2, v1, s29
    v_lshrrev_b32 v2, 22, v2
    v_mul_u32_u24 v3, 96, v2
    v_sub_u32 v3, v1, v3
    v_mul_u32_u24 v4, 96, v3
    v_add_u32 v4, v4, v2
    v_lshlrev_b32 v4, 1, v4
    buffer_load_ushort v6, v4, s[24:27], 0 offen offset:0
    buffer_load_ushort v7, v4, s[24:27], 0 offen offset:192
    buffer_load_ushort v8, v4, s[24:27], 0 offen offset:384
    buffer_load_ushort v9, v4, s[24:27], 0 offen offset:576
    s_waitcnt vmcnt(0)
    v_lshlrev_b32 v7, 16, v7
    v_or_b32 v6, v6, v7
    v_lshlrev_b32 v9, 16, v9
    v_or_b32 v7, v8, v9
    v_lshlrev_b32 v1, 1, v1
    v_add_u32 v1, 0x90000, v1
    buffer_store_dwordx2 v[6:7], v1, s[12:15], 0 offen
L_p1_end:
    s_endpgm
.section .rodata,"a"
.p2align 6
.amdhsa_kernel prep_means_kernel
  .amdhsa_next_free_vgpr 128
  .amdhsa_next_free_sgpr 40
  .amdhsa_accum_offset 128
  .amdhsa_group_segment_fixed_size 0
  .amdhsa_kernarg_size 56
  .amdhsa_user_sgpr_count 2
  .amdhsa_user_sgpr_kernarg_segment_ptr 1
  .amdhsa_system_sgpr_workgroup_id_x 1
.end_amdhsa_kernel
.text
.globl prep_kv_kernel
.p2align 8
.type prep_kv_kernel,@function
prep_kv_kernel:
    s_cmp_ge_u32 s2, 72
    s_cbranch_scc1 L_p2_end
    s_load_dwordx2 s[4:5], s[0:1], 8
    s_load_dwordx2 s[6:7], s[0:1], 48
    s_waitcnt lgkmcnt(0)
    s_mov_b32 s8, s6
    s_and_b32 s9, s7, 0xffff
    s_mov_b32 s10, 0x10000000
    s_mov_b32 s11, 0x00020000
    s_mov_b32 s12, s4
    s_and_b32 s13, s5, 0xffff
    s_mov_b32 s14, 0x4800
    s_mov_b32 s15, 0x00020000
    v_lshrrev_b32 v1, 6, v0
    v_and_b32 v2, 63, v0
    s_nop 0
    v_readfirstlane_b32 s16, v1
    v_and_b32 v3, 31, v2
    v_lshrrev_b32 v4, 5, v2
    v_mul_u32_u24 v5, 192, v3
    v_lshl_add_u32 v5, v4, 4, v5
    s_mul_i32 s17, s2, 6144
    s_mul_i32 s18, s16, 12288
    s_add_u32 s18, s18, 0x80000
    s_add_u32 s19, s18, 6144
    s_mul_i32 s20, s16, 6144
    s_add_u32 s21, s20, 0x90000
    buffer_load_dwordx4 v[8:11], v5, s[8:11], s17 offen offset:0
    buffer_load_dwordx4 v[12:15], v5, s[8:11], s17 offen offset:32
    buffer_load_dwordx4 v[16:19], v5, s[8:11], s17 offen offset:64
    buffer_load_dwordx4 v[20:23], v5, s[8:11], s17 offen offset:96
    buffer_load_dwordx4 v[24:27], v5, s[8:11], s17 offen offset:128
    buffer_load_dwordx4 v[28:31], v5, s[8:11], s17 offen offset:160
    buffer_load_dwordx4 v[32:35], v5, s[8:11], s18 offen offset:0
    buffer_load_dwordx4 v[36:39], v5, s[8:11], s18 offen offset:32
    buffer_load_dwordx4 v[40:43], v5, s[8:11], s18 offen offset:64
    buffer_load_dwordx4 v[44:47], v5, s[8:11], s18 offen offset:96
    buffer_load_dwordx4 v[48:51], v5, s[8:11], s18 offen offset:128
    buffer_load_dwordx4 v[52:55], v5, s[8:11], s18 offen offset:160
    buffer_load_dwordx4 v[56:59], v5, s[8:11], s19 offen offset:0
    buffer_load_dwordx4 v[60:63], v5, s[8:11], s19 offen offset:32
    buffer_load_dwordx4 v[64:67], v5, s[8:11], s19 offen offset:64
    buffer_load_dwordx4 v[68:71], v5, s[8:11], s19 offen offset:96
    buffer_load_dwordx4 v[72:75], v5, s[8:11], s19 offen offset:128
    buffer_load_dwordx4 v[76:79], v5, s[8:11], s19 offen offset:160
    buffer_load_dwordx4 v[80:83], v5, s[12:15], s20 offen offset:0
    buffer_load_dwordx4 v[84:87], v5, s[12:15], s20 offen offset:32
    buffer_load_dwordx4 v[88:91], v5, s[12:15], s20 offen offset:64
    buffer_load_dwordx4 v[92:95], v5, s[12:15], s20 offen offset:96
    buffer_load_dwordx4 v[96:99], v5, s[12:15], s20 offen offset:128
    buffer_load_dwordx4 v[100:103], v5, s[12:15], s20 offen offset:160
    buffer_load_dwordx4 v[104:107], v5, s[8:11], s21 offen offset:0
    buffer_load_dwordx4 v[108:111], v5, s[8:11], s21 offen offset:32
    buffer_load_dwordx4 v[112:115], v5, s[8:11], s21 offen offset:64
    buffer_load_dwordx4 v[116:119], v5, s[8:11], s21 offen offset:96
    buffer_load_dwordx4 v[120:123], v5, s[8:11], s21 offen offset:128
    buffer_load_dwordx4 v[124:127], v5, s[8:11], s21 offen offset:160
    v_mul_u32_u24 v6, 1600, v4
    v_lshl_add_u32 v6, v3, 1, v6
    s_lshl_b32 s22, s16, 7
    v_add_u32 v6, s22, v6
    s_waitcnt vmcnt(12)
    v_mfma_f32_32x32x16_bf16 v[128:143], v[8:11], v[32:35], 0
    v_mfma_f32_32x32x16_bf16 v[128:143], v[12:15], v[36:39], v[128:143]
    v_mfma_f32_32x32x16_bf16 v[128:143], v[16:19], v[40:43], v[128:143]
    v_mfma_f32_32x32x16_bf16 v[128:143], v[20:23], v[44:47], v[128:143]
    v_mfma_f32_32x32x16_bf16 v[128:143], v[24:27], v[48:51], v[128:143]
    v_mfma_f32_32x32x16_bf16 v[128:143], v[28:31], v[52:55], v[128:143]
    v_mfma_f32_32x32x16_bf16 v[144:159], v[8:11], v[56:59], 0
    v_mfma_f32_32x32x16_bf16 v[144:159], v[12:15], v[60:63], v[144:159]
    v_mfma_f32_32x32x16_bf16 v[144:159], v[16:19], v[64:67], v[144:159]
    v_mfma_f32_32x32x16_bf16 v[144:159], v[20:23], v[68:71], v[144:159]
    v_mfma_f32_32x32x16_bf16 v[144:159], v[24:27], v[72:75], v[144:159]
    v_mfma_f32_32x32x16_bf16 v[144:159], v[28:31], v[76:79], v[144:159]
    s_nop 15
    s_nop 3
    v_cvt_pk_bf16_f32 v7, v128, v129
    ds_write_b16 v6, v7 offset:0
    ds_write_b16_d16_hi v6, v7 offset:400
    v_cvt_pk_bf16_f32 v7, v130, v131
    ds_write_b16 v6, v7 offset:800
    ds_write_b16_d16_hi v6, v7 offset:1200
    v_cvt_pk_bf16_f32 v7, v132, v133
    ds_write_b16 v6, v7 offset:3200
    ds_write_b16_d16_hi v6, v7 offset:3600
    v_cvt_pk_bf16_f32 v7, v134, v135
    ds_write_b16 v6, v7 offset:4000
    ds_write_b16_d16_hi v6, v7 offset:4400
    v_cvt_pk_bf16_f32 v7, v136, v137
    ds_write_b16 v6, v7 offset:6400
    ds_write_b16_d16_hi v6, v7 offset:6800
    v_cvt_pk_bf16_f32 v7, v138, v139
    ds_write_b16 v6, v7 offset:7200
    ds_write_b16_d16_hi v6, v7 offset:7600
    v_cvt_pk_bf16_f32 v7, v140, v141
    ds_write_b16 v6, v7 offset:9600
    ds_write_b16_d16_hi v6, v7 offset:10000
    v_cvt_pk_bf16_f32 v7, v142, v143
    ds_write_b16 v6, v7 offset:10400
    ds_write_b16_d16_hi v6, v7 offset:10800
    v_cvt_pk_bf16_f32 v7, v144, v145
    ds_write_b16 v6, v7 offset:64
    ds_write_b16_d16_hi v6, v7 offset:464
    v_cvt_pk_bf16_f32 v7, v146, v147
    ds_write_b16 v6, v7 offset:864
    ds_write_b16_d16_hi v6, v7 offset:1264
    v_cvt_pk_bf16_f32 v7, v148, v149
    ds_write_b16 v6, v7 offset:3264
    ds_write_b16_d16_hi v6, v7 offset:3664
    v_cvt_pk_bf16_f32 v7, v150, v151
    ds_write_b16 v6, v7 offset:4064
    ds_write_b16_d16_hi v6, v7 offset:4464
    v_cvt_pk_bf16_f32 v7, v152, v153
    ds_write_b16 v6, v7 offset:6464
    ds_write_b16_d16_hi v6, v7 offset:6864
    v_cvt_pk_bf16_f32 v7, v154, v155
    ds_write_b16 v6, v7 offset:7264
    ds_write_b16_d16_hi v6, v7 offset:7664
    v_cvt_pk_bf16_f32 v7, v156, v157
    ds_write_b16 v6, v7 offset:9664
    ds_write_b16_d16_hi v6, v7 offset:10064
    v_cvt_pk_bf16_f32 v7, v158, v159
    ds_write_b16 v6, v7 offset:10464
    ds_write_b16_d16_hi v6, v7 offset:10864
    s_waitcnt lgkmcnt(0)
    s_barrier
    v_mul_u32_u24 v7, 400, v3
    v_lshl_add_u32 v7, v4, 4, v7
    ds_read_b128 v[8:11], v7 offset:0
    ds_read_b128 v[12:15], v7 offset:32
    ds_read_b128 v[16:19], v7 offset:64
    ds_read_b128 v[20:23], v7 offset:96
    ds_read_b128 v[24:27], v7 offset:128
    ds_read_b128 v[28:31], v7 offset:160
    ds_read_b128 v[32:35], v7 offset:192
    ds_read_b128 v[36:39], v7 offset:224
    ds_read_b128 v[40:43], v7 offset:256
    ds_read_b128 v[44:47], v7 offset:288
    ds_read_b128 v[48:51], v7 offset:320
    ds_read_b128 v[52:55], v7 offset:352
    s_waitcnt vmcnt(0) lgkmcnt(0)
    v_mfma_f32_32x32x16_bf16 v[128:143], v[8:11], v[80:83], 0
    v_mfma_f32_32x32x16_bf16 v[128:143], v[12:15], v[84:87], v[128:143]
    v_mfma_f32_32x32x16_bf16 v[128:143], v[16:19], v[88:91], v[128:143]
    v_mfma_f32_32x32x16_bf16 v[128:143], v[20:23], v[92:95], v[128:143]
    v_mfma_f32_32x32x16_bf16 v[128:143], v[24:27], v[96:99], v[128:143]
    v_mfma_f32_32x32x16_bf16 v[128:143], v[28:31], v[100:103], v[128:143]
    v_mfma_f32_32x32x16_bf16 v[144:159], v[32:35], v[104:107], 0
    v_mfma_f32_32x32x16_bf16 v[144:159], v[36:39], v[108:111], v[144:159]
    v_mfma_f32_32x32x16_bf16 v[144:159], v[40:43], v[112:115], v[144:159]
    v_mfma_f32_32x32x16_bf16 v[144:159], v[44:47], v[116:119], v[144:159]
    v_mfma_f32_32x32x16_bf16 v[144:159], v[48:51], v[120:123], v[144:159]
    v_mfma_f32_32x32x16_bf16 v[144:159], v[52:55], v[124:127], v[144:159]
    s_nop 15
    s_nop 3
    v_mul_u32_u24 v6, 832, v4
    v_lshl_add_u32 v6, v3, 1, v6
    s_lshl_b32 s22, s16, 6
    s_add_u32 s22, s22, 12800
    v_add_u32 v6, s22, v6
    s_mov_b32 s23, 0x3e16c740
    v_mul_f32 v128, s23, v128
    v_mul_f32 v129, s23, v129
    v_cvt_pk_bf16_f32 v8, v128, v129
    ds_write_b16 v6, v8 offset:0
    ds_write_b16_d16_hi v6, v8 offset:208
    v_mul_f32 v130, s23, v130
    v_mul_f32 v131, s23, v131
    v_cvt_pk_bf16_f32 v8, v130, v131
    ds_write_b16 v6, v8 offset:416
    ds_write_b16_d16_hi v6, v8 offset:624
    v_mul_f32 v132, s23, v132
    v_mul_f32 v133, s23, v133
    v_cvt_pk_bf16_f32 v8, v132, v133
    ds_write_b16 v6, v8 offset:1664
    ds_write_b16_d16_hi v6, v8 offset:1872
    v_mul_f32 v134, s23, v134
    v_mul_f32 v135, s23, v135
    v_cvt_pk_bf16_f32 v8, v134, v135
    ds_write_b16 v6, v8 offset:2080
    ds_write_b16_d16_hi v6, v8 offset:2288
    v_mul_f32 v136, s23, v136
    v_mul_f32 v137, s23, v137
    v_cvt_pk_bf16_f32 v8, v136, v137
    ds_write_b16 v6, v8 offset:3328
    ds_write_b16_d16_hi v6, v8 offset:3536
    v_mul_f32 v138, s23, v138
    v_mul_f32 v139, s23, v139
    v_cvt_pk_bf16_f32 v8, v138, v139
    ds_write_b16 v6, v8 offset:3744
    ds_write_b16_d16_hi v6, v8 offset:3952
    v_mul_f32 v140, s23, v140
    v_mul_f32 v141, s23, v141
    v_cvt_pk_bf16_f32 v8, v140, v141
    ds_write_b16 v6, v8 offset:4992
    ds_write_b16_d16_hi v6, v8 offset:5200
    v_mul_f32 v142, s23, v142
    v_mul_f32 v143, s23, v143
    v_cvt_pk_bf16_f32 v8, v142, v143
    ds_write_b16 v6, v8 offset:5408
    ds_write_b16_d16_hi v6, v8 offset:5616
    v_cvt_pk_bf16_f32 v160, v144, v145
    v_cvt_pk_bf16_f32 v161, v146, v147
    v_cvt_pk_bf16_f32 v162, v148, v149
    v_cvt_pk_bf16_f32 v163, v150, v151
    v_cvt_pk_bf16_f32 v164, v152, v153
    v_cvt_pk_bf16_f32 v165, v154, v155
    v_cvt_pk_bf16_f32 v166, v156, v157
    v_cvt_pk_bf16_f32 v167, v158, v159
    s_mul_i32 s24, s2, 12288
    s_add_u32 s24, s24, 0x100000
    v_lshlrev_b32 v9, 4, v2
    v_add_u32 v9, s24, v9
    s_lshl_b32 s25, s16, 11
    v_add_u32 v10, s25, v9
    v_add_u32 v11, 6144, v10
    buffer_store_dwordx4 v[160:163], v11, s[8:11], 0 offen offset:0
    buffer_store_dwordx4 v[164:167], v11, s[8:11], 0 offen offset:1024
    s_waitcnt lgkmcnt(0)
    v_mul_u32_u24 v7, 208, v3
    v_lshl_add_u32 v7, v4, 4, v7
    s_lshl_b32 s22, s16, 6
    s_add_u32 s22, s22, 12800
    v_add_u32 v7, s22, v7
    ds_read_b128 v[168:171], v7
    ds_read_b128 v[172:175], v7 offset:32
    s_waitcnt lgkmcnt(0)
    buffer_store_dwordx4 v[168:171], v10, s[8:11], 0 offen offset:0
    buffer_store_dwordx4 v[172:175], v10, s[8:11], 0 offen offset:1024
L_p2_end:
    s_endpgm
.section .rodata,"a"
.p2align 6
.amdhsa_kernel prep_kv_kernel
  .amdhsa_next_free_vgpr 176
  .amdhsa_next_free_sgpr 40
  .amdhsa_accum_offset 176
  .amdhsa_group_segment_fixed_size 0
  .amdhsa_kernarg_size 56
  .amdhsa_user_sgpr_count 2
  .amdhsa_user_sgpr_kernarg_segment_ptr 1
  .amdhsa_system_sgpr_workgroup_id_x 1
.end_amdhsa_kernel
.text
.globl attn_main_kernel
.p2align 8
.type attn_main_kernel,@function
attn_main_kernel:
    s_cmp_ge_u32 s2, 256
    s_cbranch_scc1 L_main_end
    s_load_dwordx2 s[40:41], s[0:1], 0
    s_load_dwordx2 s[42:43], s[0:1], 32
    s_load_dwordx2 s[44:45], s[0:1], 48
    v_lshrrev_b32 v159, 6, v0
    v_and_b32 v157, 63, v0
    v_lshlrev_b32 v157, 4, v157
    v_readfirstlane_b32 s16, v159
    s_waitcnt lgkmcnt(0)
    s_mov_b32 s4, s40
    s_and_b32 s5, s41, 0xffff
    s_mov_b32 s6, 0x1b00000
    s_mov_b32 s7, 0x00020000
    s_mov_b32 s8, s42
    s_and_b32 s9, s43, 0xffff
    s_mov_b32 s10, 0x1b00000
    s_mov_b32 s11, 0x00020000
    s_add_u32 s12, s44, 0x100000
    s_addc_u32 s13, s45, 0
    s_and_b32 s13, s13, 0xffff
    s_mov_b32 s14, 0xd8000
    s_mov_b32 s15, 0x00020000
    s_mov_b32 s28, 0x4b800000
    s_and_b32 s17, s16, 1
    s_mul_i32 s29, s2, 576
    s_lshl_b32 s30, s16, 5
    s_add_u32 s30, s30, s29
    s_mul_i32 s35, s30, 192
    s_lshr_b32 s30, s16, 1
    s_lshl_b32 s30, s30, 5
    s_add_u32 s30, s30, s29
    s_add_u32 s30, s30, 384
    s_mul_i32 s36, s30, 192
    s_lshl_b32 s37, s16, 12
    s_cmp_ge_u32 s16, 6
    s_cselect_b32 s29, 6, 0
    s_sub_u32 s29, s16, s29
    s_lshl_b32 s29, s29, 2
    s_add_u32 s30, s29, 0
    s_mul_i32 s31, s30, 43691
    s_lshr_b32 s31, s31, 18
    s_mul_i32 s23, s31, 6
    s_sub_u32 s30, s30, s23
    s_mul_i32 s23, s31, 12288
    s_lshl_b32 s30, s30, 10
    s_add_u32 s23, s23, s30
    s_sub_u32 s23, s23, 0
    s_add_u32 s30, s29, 1
    s_mul_i32 s31, s30, 43691
    s_lshr_b32 s31, s31, 18
    s_mul_i32 s24, s31, 6
    s_sub_u32 s30, s30, s24
    s_mul_i32 s24, s31, 12288
    s_lshl_b32 s30, s30, 10
    s_add_u32 s24, s24, s30
    s_sub_u32 s24, s24, 1024
    s_add_u32 s30, s29, 2
    s_mul_i32 s31, s30, 43691
    s_lshr_b32 s31, s31, 18
    s_mul_i32 s25, s31, 6
    s_sub_u32 s30, s30, s25
    s_mul_i32 s25, s31, 12288
    s_lshl_b32 s30, s30, 10
    s_add_u32 s25, s25, s30
    s_sub_u32 s25, s25, 2048
    s_add_u32 s30, s29, 3
    s_mul_i32 s31, s30, 43691
    s_lshr_b32 s31, s31, 18
    s_mul_i32 s26, s31, 6
    s_sub_u32 s30, s30, s26
    s_mul_i32 s26, s31, 12288
    s_lshl_b32 s30, s30, 10
    s_add_u32 s26, s26, s30
    s_sub_u32 s26, s26, 3072
    s_cmp_ge_u32 s16, 6
    s_cselect_b32 s22, 0xffffb800, 0
    s_cselect_b32 s32, 19, 18
    s_mov_b32 s33, 884736
    s_cselect_b32 s33, 909312, s33
    s_mov_b32 s34, 0
    s_mov_b32 s19, 0
    s_mov_b32 s20, 49152
    s_mov_b32 s21, 98304
    s_mov_b32 s21, 0
    s_add_u32 s29, s21, s37
    s_mov_b32 m0, s29
    s_add_u32 s30, s22, s23
    buffer_load_dwordx4 v157, s[12:15], s30 offen offset:0 lds
    s_add_u32 s30, s22, s24
    buffer_load_dwordx4 v157, s[12:15], s30 offen offset:1024 lds
    s_add_u32 s30, s22, s25
    buffer_load_dwordx4 v157, s[12:15], s30 offen offset:2048 lds
    s_add_u32 s30, s22, s26
    buffer_load_dwordx4 v157, s[12:15], s30 offen offset:3072 lds
    s_add_u32 s34, s34, 1
    s_add_u32 s22, s22, 49152
    s_cmp_eq_u32 s34, s32
    s_cselect_b32 s29, s33, 0
    s_sub_u32 s22, s22, s29
    s_mov_b32 s21, 49152
    s_add_u32 s29, s21, s37
    s_mov_b32 m0, s29
    s_add_u32 s30, s22, s23
    buffer_load_dwordx4 v157, s[12:15], s30 offen offset:0 lds
    s_add_u32 s30, s22, s24
    buffer_load_dwordx4 v157, s[12:15], s30 offen offset:1024 lds
    s_add_u32 s30, s22, s25
    buffer_load_dwordx4 v157, s[12:15], s30 offen offset:2048 lds
    s_add_u32 s30, s22, s26
    buffer_load_dwordx4 v157, s[12:15], s30 offen offset:3072 lds
    s_add_u32 s34, s34, 1
    s_add_u32 s22, s22, 49152
    s_cmp_eq_u32 s34, s32
    s_cselect_b32 s29, s33, 0
    s_sub_u32 s22, s22, s29
    s_mov_b32 s21, 98304
    v_lshrrev_b32 v160, 4, v157
    v_and_b32 v161, 31, v160
    v_lshrrev_b32 v160, 5, v160
    v_mul_u32_u24 v161, 192, v161
    v_lshl_add_u32 v161, v160, 4, v161
    buffer_load_dwordx4 v[96:99], v161, s[4:7], s35 offen offset:0
    buffer_load_dwordx4 v[100:103], v161, s[4:7], s35 offen offset:32
    buffer_load_dwordx4 v[104:107], v161, s[4:7], s35 offen offset:64
    buffer_load_dwordx4 v[108:111], v161, s[4:7], s35 offen offset:96
    buffer_load_dwordx4 v[112:115], v161, s[4:7], s35 offen offset:128
    buffer_load_dwordx4 v[116:119], v161, s[4:7], s35 offen offset:160
    v_mov_b32 v48, 0
    v_mov_b32 v49, 0
    v_mov_b32 v50, 0
    v_mov_b32 v51, 0
    v_mov_b32 v52, 0
    v_mov_b32 v53, 0
    v_mov_b32 v54, 0
    v_mov_b32 v55, 0
    v_mov_b32 v56, 0
    v_mov_b32 v57, 0
    v_mov_b32 v58, 0
    v_mov_b32 v59, 0
    v_mov_b32 v60, 0
    v_mov_b32 v61, 0
    v_mov_b32 v62, 0
    v_mov_b32 v63, 0
    v_mov_b32 v64, 0
    v_mov_b32 v65, 0
    v_mov_b32 v66, 0
    v_mov_b32 v67, 0
    v_mov_b32 v68, 0
    v_mov_b32 v69, 0
    v_mov_b32 v70, 0
    v_mov_b32 v71, 0
    v_mov_b32 v72, 0
    v_mov_b32 v73, 0
    v_mov_b32 v74, 0
    v_mov_b32 v75, 0
    v_mov_b32 v76, 0
    v_mov_b32 v77, 0
    v_mov_b32 v78, 0
    v_mov_b32 v79, 0
    v_mov_b32 v80, 0
    v_mov_b32 v81, 0
    v_mov_b32 v82, 0
    v_mov_b32 v83, 0
    v_mov_b32 v84, 0
    v_mov_b32 v85, 0
    v_mov_b32 v86, 0
    v_mov_b32 v87, 0
    v_mov_b32 v88, 0
    v_mov_b32 v89, 0
    v_mov_b32 v90, 0
    v_mov_b32 v91, 0
    v_mov_b32 v92, 0
    v_mov_b32 v93, 0
    v_mov_b32 v94, 0
    v_mov_b32 v95, 0
    v_mov_b32 v152, v157
    v_add_u32 v153, s20, v157
    s_mov_b32 s27, 0
    s_waitcnt vmcnt(0)
    s_barrier
    s_add_u32 s29, s21, s37
    s_mov_b32 m0, s29
    s_add_u32 s30, s22, s23
    buffer_load_dwordx4 v157, s[12:15], s30 offen offset:0 lds
    s_add_u32 s30, s22, s24
    buffer_load_dwordx4 v157, s[12:15], s30 offen offset:1024 lds
    s_add_u32 s30, s22, s25
    buffer_load_dwordx4 v157, s[12:15], s30 offen offset:2048 lds
    s_add_u32 s30, s22, s26
    buffer_load_dwordx4 v157, s[12:15], s30 offen offset:3072 lds
    s_add_u32 s34, s34, 1
    s_add_u32 s22, s22, 49152
    s_cmp_eq_u32 s34, s32
    s_cselect_b32 s29, s33, 0
    s_sub_u32 s22, s22, s29
    ds_read_b128 v[136:139], v152 offset:0
    ds_read_b128 v[140:143], v152 offset:1024
    ds_read_b128 v[144:147], v152 offset:2048
    ds_read_b128 v[148:151], v152 offset:3072
    s_waitcnt lgkmcnt(0)
    v_mfma_f32_32x32x16_bf16 v[0:15], v[136:139], v[96:99], 0
    v_mfma_f32_32x32x16_bf16 v[0:15], v[140:143], v[100:103], v[0:15]
    v_mfma_f32_32x32x16_bf16 v[0:15], v[144:147], v[104:107], v[0:15]
    v_mfma_f32_32x32x16_bf16 v[0:15], v[148:151], v[108:111], v[0:15]
    ds_read_b128 v[136:139], v152 offset:4096
    ds_read_b128 v[140:143], v152 offset:5120
    s_waitcnt lgkmcnt(0)
    v_mfma_f32_32x32x16_bf16 v[0:15], v[136:139], v[112:115], v[0:15]
    v_mfma_f32_32x32x16_bf16 v[0:15], v[140:143], v[116:119], v[0:15]
    s_nop 15
    s_nop 15
    v_max3_f32 v161, v0, v1, v2
    v_max3_f32 v161, v161, v3, v4
    v_max3_f32 v161, v161, v5, v6
    v_max3_f32 v161, v161, v7, v8
    v_max3_f32 v161, v161, v9, v10
    v_max3_f32 v161, v161, v11, v12
    v_max3_f32 v161, v161, v13, v14
    v_max_f32 v161, v161, v15
    v_mov_b32 v159, v161
    s_nop 1
    v_permlane32_swap_b32 v161, v159
    s_nop 1
    v_max_f32 v161, v161, v159
    v_sub_f32 v0, v0, v161
    v_sub_f32 v1, v1, v161
    v_sub_f32 v2, v2, v161
    v_sub_f32 v3, v3, v161
    v_sub_f32 v4, v4, v161
    v_sub_f32 v5, v5, v161
    v_sub_f32 v6, v6, v161
    v_sub_f32 v7, v7, v161
    v_sub_f32 v8, v8, v161
    v_sub_f32 v9, v9, v161
    v_sub_f32 v10, v10, v161
    v_sub_f32 v11, v11, v161
    v_sub_f32 v12, v12, v161
    v_sub_f32 v13, v13, v161
    v_sub_f32 v14, v14, v161
    v_sub_f32 v15, v15, v161
    v_exp_f32 v0, v0
    v_exp_f32 v1, v1
    v_exp_f32 v2, v2
    v_exp_f32 v3, v3
    v_exp_f32 v4, v4
    v_exp_f32 v5, v5
    v_exp_f32 v6, v6
    v_exp_f32 v7, v7
    v_exp_f32 v8, v8
    v_exp_f32 v9, v9
    v_exp_f32 v10, v10
    v_exp_f32 v11, v11
    v_exp_f32 v12, v12
    v_exp_f32 v13, v13
    v_exp_f32 v14, v14
    v_exp_f32 v15, v15
    s_nop 1
    v_add_f32 v155, v0, v1
    v_add_f32 v155, v155, v2
    v_add_f32 v155, v155, v3
    v_add_f32 v155, v155, v4
    v_add_f32 v155, v155, v5
    v_add_f32 v155, v155, v6
    v_add_f32 v155, v155, v7
    v_add_f32 v155, v155, v8
    v_add_f32 v155, v155, v9
    v_add_f32 v155, v155, v10
    v_add_f32 v155, v155, v11
    v_add_f32 v155, v155, v12
    v_add_f32 v155, v155, v13
    v_add_f32 v155, v155, v14
    v_add_f32 v155, v155, v15
    v_cvt_pk_bf16_f32 v120, v0, v1
    v_cvt_pk_bf16_f32 v121, v2, v3
    v_cvt_pk_bf16_f32 v122, v4, v5
    v_cvt_pk_bf16_f32 v123, v6, v7
    v_cvt_pk_bf16_f32 v124, v8, v9
    v_cvt_pk_bf16_f32 v125, v10, v11
    v_cvt_pk_bf16_f32 v126, v12, v13
    v_cvt_pk_bf16_f32 v127, v14, v15
    v_mov_b32 v154, v155
    v_sub_f32 v32, 0, v161
    v_sub_f32 v33, 0, v161
    v_sub_f32 v34, 0, v161
    v_sub_f32 v35, 0, v161
    v_sub_f32 v36, 0, v161
    v_sub_f32 v37, 0, v161
    v_sub_f32 v38, 0, v161
    v_sub_f32 v39, 0, v161
    v_sub_f32 v40, 0, v161
    v_sub_f32 v41, 0, v161
    v_sub_f32 v42, 0, v161
    v_sub_f32 v43, 0, v161
    v_sub_f32 v44, 0, v161
    v_sub_f32 v45, 0, v161
    v_sub_f32 v46, 0, v161
    v_sub_f32 v47, 0, v161
    s_nop 1
    ds_read_b128 v[144:147], v152 offset:6144
    s_waitcnt lgkmcnt(0)
    v_mfma_f32_32x32x16_bf16 v[16:31], v[144:147], v[96:99], v[32:47]
    ds_read_b128 v[148:151], v152 offset:7168
    ds_read_b128 v[136:139], v152 offset:8192
    ds_read_b128 v[140:143], v152 offset:9216
    s_waitcnt lgkmcnt(2)
    v_mfma_f32_32x32x16_bf16 v[16:31], v[148:151], v[100:103], v[16:31]
    ds_read_b128 v[144:147], v152 offset:10240
    s_waitcnt lgkmcnt(2)
    v_mfma_f32_32x32x16_bf16 v[16:31], v[136:139], v[104:107], v[16:31]
    ds_read_b128 v[148:151], v152 offset:11264
    s_waitcnt lgkmcnt(2)
    v_mfma_f32_32x32x16_bf16 v[16:31], v[140:143], v[108:111], v[16:31]
    s_waitcnt lgkmcnt(1)
    v_mfma_f32_32x32x16_bf16 v[16:31], v[144:147], v[112:115], v[16:31]
    s_waitcnt lgkmcnt(0)
    v_mfma_f32_32x32x16_bf16 v[16:31], v[148:151], v[116:119], v[16:31]
    s_waitcnt lgkmcnt(0)
    ds_read_b128 v[136:139], v152 offset:12288
    s_waitcnt lgkmcnt(0)
    v_mfma_f32_32x32x16_bf16 v[0:15], v[136:139], v[96:99], v[32:47]
    ds_read_b128 v[140:143], v152 offset:13312
    ds_read_b128 v[144:147], v152 offset:14336
    ds_read_b128 v[148:151], v152 offset:15360
    s_waitcnt lgkmcnt(2)
    v_mfma_f32_32x32x16_bf16 v[0:15], v[140:143], v[100:103], v[0:15]
    ds_read_b128 v[136:139], v152 offset:16384
    s_waitcnt lgkmcnt(2)
    v_mfma_f32_32x32x16_bf16 v[0:15], v[144:147], v[104:107], v[0:15]
    ds_read_b128 v[140:143], v152 offset:17408
    v_exp_f32 v16, v16
    v_exp_f32 v17, v17
    v_exp_f32 v18, v18
    s_waitcnt lgkmcnt(2)
    v_mfma_f32_32x32x16_bf16 v[0:15], v[148:151], v[108:111], v[0:15]
    ds_read_b128 v[144:147], v152 offset:36864
    v_exp_f32 v19, v19
    v_cvt_pk_bf16_f32 v128, v16, v17
    v_exp_f32 v20, v20
    s_waitcnt lgkmcnt(2)
    v_mfma_f32_32x32x16_bf16 v[0:15], v[136:139], v[112:115], v[0:15]
    ds_read_b128 v[148:151], v152 offset:37888
    v_exp_f32 v21, v21
    v_add_f32 v155, v16, v18
    v_add_f32 v156, v17, v19
    v_cvt_pk_bf16_f32 v129, v18, v19
    s_waitcnt lgkmcnt(2)
    v_mfma_f32_32x32x16_bf16 v[0:15], v[140:143], v[116:119], v[0:15]
    ds_read_b128 v[136:139], v152 offset:38912
    v_exp_f32 v22, v22
    v_exp_f32 v23, v23
    v_add_f32 v155, v20, v155
    v_add_f32 v156, v21, v156
    s_waitcnt lgkmcnt(2)
    v_mfma_f32_32x32x16_bf16 v[48:63], v[144:147], v[120:123], v[48:63]
    ds_read_b128 v[140:143], v152 offset:39936
    v_cvt_pk_bf16_f32 v130, v20, v21
    v_exp_f32 v24, v24
    v_exp_f32 v25, v25
    s_waitcnt lgkmcnt(2)
    v_mfma_f32_32x32x16_bf16 v[48:63], v[148:151], v[124:127], v[48:63]
    ds_read_b128 v[144:147], v152 offset:40960
    v_add_f32 v155, v22, v155
    v_add_f32 v156, v23, v156
    v_cvt_pk_bf16_f32 v131, v22, v23
    v_exp_f32 v26, v26
    s_waitcnt lgkmcnt(2)
    v_mfma_f32_32x32x16_bf16 v[64:79], v[136:139], v[120:123], v[64:79]
    ds_read_b128 v[148:151], v152 offset:41984
    v_exp_f32 v27, v27
    v_add_f32 v155, v24, v155
    v_add_f32 v156, v25, v156
    v_cvt_pk_bf16_f32 v132, v24, v25
    v_exp_f32 v28, v28
    s_waitcnt lgkmcnt(2)
    v_mfma_f32_32x32x16_bf16 v[64:79], v[140:143], v[124:127], v[64:79]
    ds_read_b128 v[136:139], v152 offset:18432
    v_exp_f32 v29, v29
    v_add_f32 v155, v26, v155
    v_add_f32 v156, v27, v156
    v_cvt_pk_bf16_f32 v133, v26, v27
    s_waitcnt lgkmcnt(2)
    v_mfma_f32_32x32x16_bf16 v[80:95], v[144:147], v[120:123], v[80:95]
    ds_read_b128 v[140:143], v152 offset:19456
    v_exp_f32 v30, v30
    v_exp_f32 v31, v31
    v_add_f32 v155, v28, v155
    s_waitcnt lgkmcnt(2)
    v_mfma_f32_32x32x16_bf16 v[80:95], v[148:151], v[124:127], v[80:95]
    ds_read_b128 v[144:147], v152 offset:20480
    v_add_f32 v156, v29, v156
    v_cvt_pk_bf16_f32 v134, v28, v29
    v_add_f32 v155, v30, v155
    v_add_f32 v156, v31, v156
    v_cvt_pk_bf16_f32 v135, v30, v31
    v_add_f32 v155, v155, v156
    v_cmp_nge_f32 vcc, s28, v155
    s_cbranch_vccnz L_slow_1
L_back_2:
    v_add_f32 v154, v154, v155
    s_waitcnt lgkmcnt(2)
    v_mfma_f32_32x32x16_bf16 v[16:31], v[136:139], v[96:99], v[32:47]
    ds_read_b128 v[148:151], v152 offset:21504
    v_exp_f32 v0, v0
    v_exp_f32 v1, v1
    s_waitcnt lgkmcnt(2)
    v_mfma_f32_32x32x16_bf16 v[16:31], v[140:143], v[100:103], v[16:31]
    ds_read_b128 v[136:139], v152 offset:22528
    v_exp_f32 v2, v2
    v_exp_f32 v3, v3
    v_cvt_pk_bf16_f32 v120, v0, v1
    s_waitcnt lgkmcnt(2)
    v_mfma_f32_32x32x16_bf16 v[16:31], v[144:147], v[104:107], v[16:31]
    ds_read_b128 v[140:143], v152 offset:23552
    v_exp_f32 v4, v4
    v_exp_f32 v5, v5
    v_add_f32 v155, v0, v2
    s_waitcnt lgkmcnt(2)
    v_mfma_f32_32x32x16_bf16 v[16:31], v[148:151], v[108:111], v[16:31]
    ds_read_b128 v[144:147], v152 offset:43008
    v_add_f32 v156, v1, v3
    v_cvt_pk_bf16_f32 v121, v2, v3
    v_exp_f32 v6, v6
    s_waitcnt lgkmcnt(2)
    v_mfma_f32_32x32x16_bf16 v[16:31], v[136:139], v[112:115], v[16:31]
    ds_read_b128 v[148:151], v152 offset:44032
    v_exp_f32 v7, v7
    v_add_f32 v155, v4, v155
    v_add_f32 v156, v5, v156
    v_cvt_pk_bf16_f32 v122, v4, v5
    s_waitcnt lgkmcnt(2)
    v_mfma_f32_32x32x16_bf16 v[16:31], v[140:143], v[116:119], v[16:31]
    ds_read_b128 v[136:139], v152 offset:45056
    v_exp_f32 v8, v8
    v_exp_f32 v9, v9
    s_waitcnt lgkmcnt(2)
    v_mfma_f32_32x32x16_bf16 v[48:63], v[144:147], v[128:131], v[48:63]
    ds_read_b128 v[140:143], v152 offset:46080
    v_add_f32 v155, v6, v155
    v_add_f32 v156, v7, v156
    v_cvt_pk_bf16_f32 v123, v6, v7
    v_exp_f32 v10, v10
    s_waitcnt lgkmcnt(2)
    v_mfma_f32_32x32x16_bf16 v[48:63], v[148:151], v[132:135], v[48:63]
    ds_read_b128 v[144:147], v152 offset:47104
    v_exp_f32 v11, v11
    v_add_f32 v155, v8, v155
    v_add_f32 v156, v9, v156
    v_cvt_pk_bf16_f32 v124, v8, v9
    s_waitcnt lgkmcnt(2)
    v_mfma_f32_32x32x16_bf16 v[64:79], v[136:139], v[128:131], v[64:79]
    ds_read_b128 v[148:151], v152 offset:48128
    v_exp_f32 v12, v12
    v_exp_f32 v13, v13
    s_waitcnt lgkmcnt(2)
    v_mfma_f32_32x32x16_bf16 v[64:79], v[140:143], v[132:135], v[64:79]
    ds_read_b128 v[136:139], v153 offset:0
    v_add_f32 v155, v10, v155
    v_add_f32 v156, v11, v156
    v_cvt_pk_bf16_f32 v125, v10, v11
    v_exp_f32 v14, v14
    s_waitcnt lgkmcnt(2)
    v_mfma_f32_32x32x16_bf16 v[80:95], v[144:147], v[128:131], v[80:95]
    ds_read_b128 v[140:143], v153 offset:1024
    v_exp_f32 v15, v15
    v_add_f32 v155, v12, v155
    v_add_f32 v156, v13, v156
    s_waitcnt lgkmcnt(2)
    v_mfma_f32_32x32x16_bf16 v[80:95], v[148:151], v[132:135], v[80:95]
    ds_read_b128 v[144:147], v153 offset:2048
    v_cvt_pk_bf16_f32 v126, v12, v13
    v_add_f32 v155, v14, v155
    v_add_f32 v156, v15, v156
    v_cvt_pk_bf16_f32 v127, v14, v15
    v_add_f32 v155, v155, v156
    v_cmp_nge_f32 vcc, s28, v155
    s_cbranch_vccnz L_slow_3
L_back_4:
    v_add_f32 v154, v154, v155
    s_mov_b32 s18, 17
L_r1:
    s_mov_b32 s29, s19
    s_mov_b32 s19, s20
    s_mov_b32 s20, s21
    s_mov_b32 s21, s29
    v_add_u32 v152, s19, v157
    v_add_u32 v153, s20, v157
    s_add_u32 s29, s21, s37
    s_mov_b32 m0, s29
    s_add_u32 s40, s22, s23
    s_add_u32 s41, s22, s24
    s_add_u32 s42, s22, s25
    s_add_u32 s43, s22, s26
    s_add_u32 s34, s34, 1
    s_add_u32 s22, s22, 49152
    s_cmp_eq_u32 s34, s32
    s_cselect_b32 s29, s33, 0
    s_sub_u32 s22, s22, s29
    s_waitcnt vmcnt(0)
    s_barrier
    s_add_u32 s27, s27, 49152
    s_waitcnt lgkmcnt(2)
    v_mfma_f32_32x32x16_bf16 v[0:15], v[136:139], v[96:99], v[32:47]
    ds_read_b128 v[148:151], v152 offset:3072
    v_exp_f32 v16, v16
    v_exp_f32 v17, v17
    s_waitcnt lgkmcnt(2)
    v_mfma_f32_32x32x16_bf16 v[0:15], v[140:143], v[100:103], v[0:15]
    ds_read_b128 v[136:139], v152 offset:4096
    buffer_load_dwordx4 v157, s[12:15], s40 offen offset:0 lds
    v_exp_f32 v18, v18
    v_exp_f32 v19, v19
    v_cvt_pk_bf16_f32 v128, v16, v17
    s_waitcnt lgkmcnt(2)
    v_mfma_f32_32x32x16_bf16 v[0:15], v[144:147], v[104:107], v[0:15]
    ds_read_b128 v[140:143], v152 offset:5120
    v_exp_f32 v20, v20
    v_exp_f32 v21, v21
    v_add_f32 v155, v16, v18
    s_waitcnt lgkmcnt(2)
    v_mfma_f32_32x32x16_bf16 v[0:15], v[148:151], v[108:111], v[0:15]
    ds_read_b128 v[144:147], v152 offset:24576
    v_add_f32 v156, v17, v19
    v_cvt_pk_bf16_f32 v129, v18, v19
    v_exp_f32 v22, v22
    s_waitcnt lgkmcnt(2)
    v_mfma_f32_32x32x16_bf16 v[0:15], v[136:139], v[112:115], v[0:15]
    ds_read_b128 v[148:151], v152 offset:25600
    buffer_load_dwordx4 v157, s[12:15], s41 offen offset:1024 lds
    v_exp_f32 v23, v23
    v_add_f32 v155, v20, v155
    v_add_f32 v156, v21, v156
    v_cvt_pk_bf16_f32 v130, v20, v21
    s_waitcnt lgkmcnt(2)
    v_mfma_f32_32x32x16_bf16 v[0:15], v[140:143], v[116:119], v[0:15]
    ds_read_b128 v[136:139], v152 offset:26624
    v_exp_f32 v24, v24
    v_exp_f32 v25, v25
    s_waitcnt lgkmcnt(2)
    v_mfma_f32_32x32x16_bf16 v[48:63], v[144:147], v[120:123], v[48:63]
    ds_read_b128 v[140:143], v152 offset:27648
    v_add_f32 v155, v22, v155
    v_add_f32 v156, v23, v156
    v_cvt_pk_bf16_f32 v131, v22, v23
    v_exp_f32 v26, v26
    s_waitcnt lgkmcnt(2)
    v_mfma_f32_32x32x16_bf16 v[48:63], v[148:151], v[124:127], v[48:63]
    ds_read_b128 v[144:147], v152 offset:28672
    buffer_load_dwordx4 v157, s[12:15], s42 offen offset:2048 lds
    v_exp_f32 v27, v27
    v_add_f32 v155, v24, v155
    v_add_f32 v156, v25, v156
    v_cvt_pk_bf16_f32 v132, v24, v25
    s_waitcnt lgkmcnt(2)
    v_mfma_f32_32x32x16_bf16 v[64:79], v[136:139], v[120:123], v[64:79]
    ds_read_b128 v[148:151], v152 offset:29696
    v_exp_f32 v28, v28
    v_exp_f32 v29, v29
    s_waitcnt lgkmcnt(2)
    v_mfma_f32_32x32x16_bf16 v[64:79], v[140:143], v[124:127], v[64:79]
    ds_read_b128 v[136:139], v152 offset:6144
    v_add_f32 v155, v26, v155
    v_add_f32 v156, v27, v156
    v_cvt_pk_bf16_f32 v133, v26, v27
    v_exp_f32 v30, v30
    s_waitcnt lgkmcnt(2)
    v_mfma_f32_32x32x16_bf16 v[80:95], v[144:147], v[120:123], v[80:95]
    ds_read_b128 v[140:143], v152 offset:7168
    buffer_load_dwordx4 v157, s[12:15], s43 offen offset:3072 lds
    v_exp_f32 v31, v31
    v_add_f32 v155, v28, v155
    v_add_f32 v156, v29, v156
    s_waitcnt lgkmcnt(2)
    v_mfma_f32_32x32x16_bf16 v[80:95], v[148:151], v[124:127], v[80:95]
    ds_read_b128 v[144:147], v152 offset:8192
    v_cvt_pk_bf16_f32 v134, v28, v29
    v_add_f32 v155, v30, v155
    v_add_f32 v156, v31, v156
    v_cvt_pk_bf16_f32 v135, v30, v31
    v_add_f32 v155, v155, v156
    v_cmp_nge_f32 vcc, s28, v155
    s_cbranch_vccnz L_slow_5
L_back_6:
    v_add_f32 v154, v154, v155
    s_waitcnt lgkmcnt(2)
    v_mfma_f32_32x32x16_bf16 v[16:31], v[136:139], v[96:99], v[32:47]
    ds_read_b128 v[148:151], v152 offset:9216
    v_exp_f32 v0, v0
    v_exp_f32 v1, v1
    s_waitcnt lgkmcnt(2)
    v_mfma_f32_32x32x16_bf16 v[16:31], v[140:143], v[100:103], v[16:31]
    ds_read_b128 v[136:139], v152 offset:10240
    v_exp_f32 v2, v2
    v_exp_f32 v3, v3
    v_cvt_pk_bf16_f32 v120, v0, v1
    s_waitcnt lgkmcnt(2)
    v_mfma_f32_32x32x16_bf16 v[16:31], v[144:147], v[104:107], v[16:31]
    ds_read_b128 v[140:143], v152 offset:11264
    v_exp_f32 v4, v4
    v_exp_f32 v5, v5
    v_add_f32 v155, v0, v2
    s_waitcnt lgkmcnt(2)
    v_mfma_f32_32x32x16_bf16 v[16:31], v[148:151], v[108:111], v[16:31]
    ds_read_b128 v[144:147], v152 offset:30720
    v_add_f32 v156, v1, v3
    v_cvt_pk_bf16_f32 v121, v2, v3
    v_exp_f32 v6, v6
    s_waitcnt lgkmcnt(2)
    v_mfma_f32_32x32x16_bf16 v[16:31], v[136:139], v[112:115], v[16:31]
    ds_read_b128 v[148:151], v152 offset:31744
    v_exp_f32 v7, v7
    v_add_f32 v155, v4, v155
    v_add_f32 v156, v5, v156
    v_cvt_pk_bf16_f32 v122, v4, v5
    s_waitcnt lgkmcnt(2)
    v_mfma_f32_32x32x16_bf16 v[16:31], v[140:143], v[116:119], v[16:31]
    ds_read_b128 v[136:139], v152 offset:32768
    v_exp_f32 v8, v8
    v_exp_f32 v9, v9
    s_waitcnt lgkmcnt(2)
    v_mfma_f32_32x32x16_bf16 v[48:63], v[144:147], v[128:131], v[48:63]
    ds_read_b128 v[140:143], v152 offset:33792
    v_add_f32 v155, v6, v155
    v_add_f32 v156, v7, v156
    v_cvt_pk_bf16_f32 v123, v6, v7
    v_exp_f32 v10, v10
    s_waitcnt lgkmcnt(2)
    v_mfma_f32_32x32x16_bf16 v[48:63], v[148:151], v[132:135], v[48:63]
    ds_read_b128 v[144:147], v152 offset:34816
    v_exp_f32 v11, v11
    v_add_f32 v155, v8, v155
    v_add_f32 v156, v9, v156
    v_cvt_pk_bf16_f32 v124, v8, v9
    s_waitcnt lgkmcnt(2)
    v_mfma_f32_32x32x16_bf16 v[64:79], v[136:139], v[128:131], v[64:79]
    ds_read_b128 v[148:151], v152 offset:35840
    v_exp_f32 v12, v12
    v_exp_f32 v13, v13
    s_waitcnt lgkmcnt(2)
    v_mfma_f32_32x32x16_bf16 v[64:79], v[140:143], v[132:135], v[64:79]
    ds_read_b128 v[136:139], v152 offset:12288
    v_add_f32 v155, v10, v155
    v_add_f32 v156, v11, v156
    v_cvt_pk_bf16_f32 v125, v10, v11
    v_exp_f32 v14, v14
    s_waitcnt lgkmcnt(2)
    v_mfma_f32_32x32x16_bf16 v[80:95], v[144:147], v[128:131], v[80:95]
    ds_read_b128 v[140:143], v152 offset:13312
    v_exp_f32 v15, v15
    v_add_f32 v155, v12, v155
    v_add_f32 v156, v13, v156
    s_waitcnt lgkmcnt(2)
    v_mfma_f32_32x32x16_bf16 v[80:95], v[148:151], v[132:135], v[80:95]
    ds_read_b128 v[144:147], v152 offset:14336
    v_cvt_pk_bf16_f32 v126, v12, v13
    v_add_f32 v155, v14, v155
    v_add_f32 v156, v15, v156
    v_cvt_pk_bf16_f32 v127, v14, v15
    v_add_f32 v155, v155, v156
    v_cmp_nge_f32 vcc, s28, v155
    s_cbranch_vccnz L_slow_7
L_back_8:
    v_add_f32 v154, v154, v155
    s_waitcnt lgkmcnt(2)
    v_mfma_f32_32x32x16_bf16 v[0:15], v[136:139], v[96:99], v[32:47]
    ds_read_b128 v[148:151], v152 offset:15360
    v_exp_f32 v16, v16
    v_exp_f32 v17, v17
    s_waitcnt lgkmcnt(2)
    v_mfma_f32_32x32x16_bf16 v[0:15], v[140:143], v[100:103], v[0:15]
    ds_read_b128 v[136:139], v152 offset:16384
    v_exp_f32 v18, v18
    v_exp_f32 v19, v19
    v_cvt_pk_bf16_f32 v128, v16, v17
    s_waitcnt lgkmcnt(2)
    v_mfma_f32_32x32x16_bf16 v[0:15], v[144:147], v[104:107], v[0:15]
    ds_read_b128 v[140:143], v152 offset:17408
    v_exp_f32 v20, v20
    v_exp_f32 v21, v21
    v_add_f32 v155, v16, v18
    s_waitcnt lgkmcnt(2)
    v_mfma_f32_32x32x16_bf16 v[0:15], v[148:151], v[108:111], v[0:15]
    ds_read_b128 v[144:147], v152 offset:36864
    v_add_f32 v156, v17, v19
    v_cvt_pk_bf16_f32 v129, v18, v19
    v_exp_f32 v22, v22
    s_waitcnt lgkmcnt(2)
    v_mfma_f32_32x32x16_bf16 v[0:15], v[136:139], v[112:115], v[0:15]
    ds_read_b128 v[148:151], v152 offset:37888
    v_exp_f32 v23, v23
    v_add_f32 v155, v20, v155
    v_add_f32 v156, v21, v156
    v_cvt_pk_bf16_f32 v130, v20, v21
    s_waitcnt lgkmcnt(2)
    v_mfma_f32_32x32x16_bf16 v[0:15], v[140:143], v[116:119], v[0:15]
    ds_read_b128 v[136:139], v152 offset:38912
    v_exp_f32 v24, v24
    v_exp_f32 v25, v25
    s_waitcnt lgkmcnt(2)
    v_mfma_f32_32x32x16_bf16 v[48:63], v[144:147], v[120:123], v[48:63]
    ds_read_b128 v[140:143], v152 offset:39936
    v_add_f32 v155, v22, v155
    v_add_f32 v156, v23, v156
    v_cvt_pk_bf16_f32 v131, v22, v23
    v_exp_f32 v26, v26
    s_waitcnt lgkmcnt(2)
    v_mfma_f32_32x32x16_bf16 v[48:63], v[148:151], v[124:127], v[48:63]
    ds_read_b128 v[144:147], v152 offset:40960
    v_exp_f32 v27, v27
    v_add_f32 v155, v24, v155
    v_add_f32 v156, v25, v156
    v_cvt_pk_bf16_f32 v132, v24, v25
    s_waitcnt lgkmcnt(2)
    v_mfma_f32_32x32x16_bf16 v[64:79], v[136:139], v[120:123], v[64:79]
    ds_read_b128 v[148:151], v152 offset:41984
    v_exp_f32 v28, v28
    v_exp_f32 v29, v29
    s_waitcnt lgkmcnt(2)
    v_mfma_f32_32x32x16_bf16 v[64:79], v[140:143], v[124:127], v[64:79]
    ds_read_b128 v[136:139], v152 offset:18432
    v_add_f32 v155, v26, v155
    v_add_f32 v156, v27, v156
    v_cvt_pk_bf16_f32 v133, v26, v27
    v_exp_f32 v30, v30
    s_waitcnt lgkmcnt(2)
    v_mfma_f32_32x32x16_bf16 v[80:95], v[144:147], v[120:123], v[80:95]
    ds_read_b128 v[140:143], v152 offset:19456
    v_exp_f32 v31, v31
    v_add_f32 v155, v28, v155
    v_add_f32 v156, v29, v156
    s_waitcnt lgkmcnt(2)
    v_mfma_f32_32x32x16_bf16 v[80:95], v[148:151], v[124:127], v[80:95]
    ds_read_b128 v[144:147], v152 offset:20480
    v_cvt_pk_bf16_f32 v134, v28, v29
    v_add_f32 v155, v30, v155
    v_add_f32 v156, v31, v156
    v_cvt_pk_bf16_f32 v135, v30, v31
    v_add_f32 v155, v155, v156
    v_cmp_nge_f32 vcc, s28, v155
    s_cbranch_vccnz L_slow_9
L_back_10:
    v_add_f32 v154, v154, v155
    s_waitcnt lgkmcnt(2)
    v_mfma_f32_32x32x16_bf16 v[16:31], v[136:139], v[96:99], v[32:47]
    ds_read_b128 v[148:151], v152 offset:21504
    v_exp_f32 v0, v0
    v_exp_f32 v1, v1
    s_waitcnt lgkmcnt(2)
    v_mfma_f32_32x32x16_bf16 v[16:31], v[140:143], v[100:103], v[16:31]
    ds_read_b128 v[136:139], v152 offset:22528
    v_exp_f32 v2, v2
    v_exp_f32 v3, v3
    v_cvt_pk_bf16_f32 v120, v0, v1
    s_waitcnt lgkmcnt(2)
    v_mfma_f32_32x32x16_bf16 v[16:31], v[144:147], v[104:107], v[16:31]
    ds_read_b128 v[140:143], v152 offset:23552
    v_exp_f32 v4, v4
    v_exp_f32 v5, v5
    v_add_f32 v155, v0, v2
    s_waitcnt lgkmcnt(2)
    v_mfma_f32_32x32x16_bf16 v[16:31], v[148:151], v[108:111], v[16:31]
    ds_read_b128 v[144:147], v152 offset:43008
    v_add_f32 v156, v1, v3
    v_cvt_pk_bf16_f32 v121, v2, v3
    v_exp_f32 v6, v6
    s_waitcnt lgkmcnt(2)
    v_mfma_f32_32x32x16_bf16 v[16:31], v[136:139], v[112:115], v[16:31]
    ds_read_b128 v[148:151], v152 offset:44032
    v_exp_f32 v7, v7
    v_add_f32 v155, v4, v155
    v_add_f32 v156, v5, v156
    v_cvt_pk_bf16_f32 v122, v4, v5
    s_waitcnt lgkmcnt(2)
    v_mfma_f32_32x32x16_bf16 v[16:31], v[140:143], v[116:119], v[16:31]
    ds_read_b128 v[136:139], v152 offset:45056
    v_exp_f32 v8, v8
    v_exp_f32 v9, v9
    s_waitcnt lgkmcnt(2)
    v_mfma_f32_32x32x16_bf16 v[48:63], v[144:147], v[128:131], v[48:63]
    ds_read_b128 v[140:143], v152 offset:46080
    v_add_f32 v155, v6, v155
    v_add_f32 v156, v7, v156
    v_cvt_pk_bf16_f32 v123, v6, v7
    v_exp_f32 v10, v10
    s_waitcnt lgkmcnt(2)
    v_mfma_f32_32x32x16_bf16 v[48:63], v[148:151], v[132:135], v[48:63]
    ds_read_b128 v[144:147], v152 offset:47104
    v_exp_f32 v11, v11
    v_add_f32 v155, v8, v155
    v_add_f32 v156, v9, v156
    v_cvt_pk_bf16_f32 v124, v8, v9
    s_waitcnt lgkmcnt(2)
    v_mfma_f32_32x32x16_bf16 v[64:79], v[136:139], v[128:131], v[64:79]
    ds_read_b128 v[148:151], v152 offset:48128
    v_exp_f32 v12, v12
    v_exp_f32 v13, v13
    s_waitcnt lgkmcnt(2)
    v_mfma_f32_32x32x16_bf16 v[64:79], v[140:143], v[132:135], v[64:79]
    ds_read_b128 v[136:139], v153 offset:0
    v_add_f32 v155, v10, v155
    v_add_f32 v156, v11, v156
    v_cvt_pk_bf16_f32 v125, v10, v11
    v_exp_f32 v14, v14
    s_waitcnt lgkmcnt(2)
    v_mfma_f32_32x32x16_bf16 v[80:95], v[144:147], v[128:131], v[80:95]
    ds_read_b128 v[140:143], v153 offset:1024
    v_exp_f32 v15, v15
    v_add_f32 v155, v12, v155
    v_add_f32 v156, v13, v156
    s_waitcnt lgkmcnt(2)
    v_mfma_f32_32x32x16_bf16 v[80:95], v[148:151], v[132:135], v[80:95]
    ds_read_b128 v[144:147], v153 offset:2048
    v_cvt_pk_bf16_f32 v126, v12, v13
    v_add_f32 v155, v14, v155
    v_add_f32 v156, v15, v156
    v_cvt_pk_bf16_f32 v127, v14, v15
    v_add_f32 v155, v155, v156
    v_cmp_nge_f32 vcc, s28, v155
    s_cbranch_vccnz L_slow_11
L_back_12:
    v_add_f32 v154, v154, v155
    s_sub_u32 s18, s18, 1
    s_cmp_lg_u32 s18, 0
    s_cbranch_scc1 L_r1
    s_waitcnt lgkmcnt(0)
    s_mul_i32 s29, s17, 6144
    v_add_u32 v158, s29, v157
    s_waitcnt vmcnt(0)
    s_barrier
    s_mov_b32 s29, s19
    s_mov_b32 s19, s20
    s_mov_b32 s20, s21
    s_mov_b32 s21, s29
    v_add_u32 v152, s19, v157
    v_add_u32 v153, s20, v157
    s_add_u32 s29, s21, s37
    s_mov_b32 m0, s29
    s_add_u32 s30, s22, s23
    buffer_load_dwordx4 v157, s[12:15], s30 offen offset:0 lds
    s_add_u32 s30, s22, s24
    buffer_load_dwordx4 v157, s[12:15], s30 offen offset:1024 lds
    s_add_u32 s30, s22, s25
    buffer_load_dwordx4 v157, s[12:15], s30 offen offset:2048 lds
    s_add_u32 s30, s22, s26
    buffer_load_dwordx4 v157, s[12:15], s30 offen offset:3072 lds
    s_add_u32 s34, s34, 1
    s_add_u32 s22, s22, 49152
    s_cmp_eq_u32 s34, s32
    s_cselect_b32 s29, s33, 0
    s_sub_u32 s22, s22, s29
    ds_read_b128 v[144:147], v152 offset:24576
    s_waitcnt lgkmcnt(0)
    v_mfma_f32_32x32x16_bf16 v[48:63], v[144:147], v[120:123], v[48:63]
    ds_read_b128 v[148:151], v152 offset:25600
    ds_read_b128 v[136:139], v152 offset:26624
    ds_read_b128 v[140:143], v152 offset:27648
    v_exp_f32 v16, v16
    v_exp_f32 v17, v17
    v_exp_f32 v18, v18
    v_exp_f32 v19, v19
    v_cvt_pk_bf16_f32 v128, v16, v17
    s_waitcnt lgkmcnt(2)
    v_mfma_f32_32x32x16_bf16 v[48:63], v[148:151], v[124:127], v[48:63]
    ds_read_b128 v[144:147], v152 offset:28672
    v_exp_f32 v20, v20
    v_exp_f32 v21, v21
    v_add_f32 v155, v16, v18
    v_add_f32 v156, v17, v19
    v_cvt_pk_bf16_f32 v129, v18, v19
    v_exp_f32 v22, v22
    s_waitcnt lgkmcnt(2)
    v_mfma_f32_32x32x16_bf16 v[64:79], v[136:139], v[120:123], v[64:79]
    ds_read_b128 v[148:151], v152 offset:29696
    v_exp_f32 v23, v23
    v_add_f32 v155, v20, v155
    v_add_f32 v156, v21, v156
    v_cvt_pk_bf16_f32 v130, v20, v21
    v_exp_f32 v24, v24
    v_exp_f32 v25, v25
    s_waitcnt lgkmcnt(2)
    v_mfma_f32_32x32x16_bf16 v[64:79], v[140:143], v[124:127], v[64:79]
    v_add_f32 v155, v22, v155
    v_add_f32 v156, v23, v156
    v_cvt_pk_bf16_f32 v131, v22, v23
    v_exp_f32 v26, v26
    v_exp_f32 v27, v27
    v_add_f32 v155, v24, v155
    v_add_f32 v156, v25, v156
    v_cvt_pk_bf16_f32 v132, v24, v25
    s_waitcnt lgkmcnt(1)
    v_mfma_f32_32x32x16_bf16 v[80:95], v[144:147], v[120:123], v[80:95]
    v_exp_f32 v28, v28
    v_exp_f32 v29, v29
    v_add_f32 v155, v26, v155
    v_add_f32 v156, v27, v156
    v_cvt_pk_bf16_f32 v133, v26, v27
    v_exp_f32 v30, v30
    s_waitcnt lgkmcnt(0)
    v_mfma_f32_32x32x16_bf16 v[80:95], v[148:151], v[124:127], v[80:95]
    v_exp_f32 v31, v31
    v_add_f32 v155, v28, v155
    v_add_f32 v156, v29, v156
    v_cvt_pk_bf16_f32 v134, v28, v29
    v_add_f32 v155, v30, v155
    v_add_f32 v156, v31, v156
    v_cvt_pk_bf16_f32 v135, v30, v31
    v_add_f32 v155, v155, v156
    v_cmp_nge_f32 vcc, s28, v155
    s_cbranch_vccnz L_slow_13
L_back_14:
    v_add_f32 v154, v154, v155
    s_nop 1
    ds_read_b128 v[144:147], v152 offset:30720
    s_waitcnt lgkmcnt(0)
    v_mfma_f32_32x32x16_bf16 v[48:63], v[144:147], v[128:131], v[48:63]
    ds_read_b128 v[148:151], v152 offset:31744
    ds_read_b128 v[136:139], v152 offset:32768
    ds_read_b128 v[140:143], v152 offset:33792
    s_waitcnt lgkmcnt(2)
    v_mfma_f32_32x32x16_bf16 v[48:63], v[148:151], v[132:135], v[48:63]
    ds_read_b128 v[144:147], v152 offset:34816
    s_waitcnt lgkmcnt(2)
    v_mfma_f32_32x32x16_bf16 v[64:79], v[136:139], v[128:131], v[64:79]
    ds_read_b128 v[148:151], v152 offset:35840
    s_waitcnt lgkmcnt(2)
    v_mfma_f32_32x32x16_bf16 v[64:79], v[140:143], v[132:135], v[64:79]
    s_waitcnt lgkmcnt(1)
    v_mfma_f32_32x32x16_bf16 v[80:95], v[144:147], v[128:131], v[80:95]
    s_waitcnt lgkmcnt(0)
    v_mfma_f32_32x32x16_bf16 v[80:95], v[148:151], v[132:135], v[80:95]
    v_lshrrev_b32 v160, 4, v157
    v_and_b32 v161, 31, v160
    v_lshrrev_b32 v160, 5, v160
    v_mul_u32_u24 v161, 192, v161
    v_lshl_add_u32 v161, v160, 4, v161
    buffer_load_dwordx4 v[96:99], v161, s[4:7], s36 offen offset:0
    buffer_load_dwordx4 v[100:103], v161, s[4:7], s36 offen offset:32
    buffer_load_dwordx4 v[104:107], v161, s[4:7], s36 offen offset:64
    buffer_load_dwordx4 v[108:111], v161, s[4:7], s36 offen offset:96
    buffer_load_dwordx4 v[112:115], v161, s[4:7], s36 offen offset:128
    buffer_load_dwordx4 v[116:119], v161, s[4:7], s36 offen offset:160
    s_nop 15
    s_nop 7
    v_mov_b32 v159, v154
    v_mov_b32 v160, v154
    s_nop 1
    v_permlane32_swap_b32 v159, v160
    s_nop 1
    v_add_f32 v159, v159, v160
    v_rcp_f32 v159, v159
    v_lshrrev_b32 v160, 4, v157
    v_and_b32 v161, 31, v160
    v_lshrrev_b32 v160, 5, v160
    v_mul_u32_u24 v161, 192, v161
    v_lshl_add_u32 v161, v160, 3, v161
    v_add_u32 v165, s35, v161
    v_mul_f32 v48, v48, v159
    v_mul_f32 v49, v49, v159
    v_mul_f32 v50, v50, v159
    v_mul_f32 v51, v51, v159
    v_cvt_pk_bf16_f32 v0, v48, v49
    v_cvt_pk_bf16_f32 v1, v50, v51
    buffer_store_dwordx2 v[0:1], v165, s[8:11], 0 offen offset:0
    v_mul_f32 v52, v52, v159
    v_mul_f32 v53, v53, v159
    v_mul_f32 v54, v54, v159
    v_mul_f32 v55, v55, v159
    v_cvt_pk_bf16_f32 v2, v52, v53
    v_cvt_pk_bf16_f32 v3, v54, v55
    buffer_store_dwordx2 v[2:3], v165, s[8:11], 0 offen offset:16
    v_mul_f32 v56, v56, v159
    v_mul_f32 v57, v57, v159
    v_mul_f32 v58, v58, v159
    v_mul_f32 v59, v59, v159
    v_cvt_pk_bf16_f32 v4, v56, v57
    v_cvt_pk_bf16_f32 v5, v58, v59
    buffer_store_dwordx2 v[4:5], v165, s[8:11], 0 offen offset:32
    v_mul_f32 v60, v60, v159
    v_mul_f32 v61, v61, v159
    v_mul_f32 v62, v62, v159
    v_mul_f32 v63, v63, v159
    v_cvt_pk_bf16_f32 v6, v60, v61
    v_cvt_pk_bf16_f32 v7, v62, v63
    buffer_store_dwordx2 v[6:7], v165, s[8:11], 0 offen offset:48
    v_mul_f32 v64, v64, v159
    v_mul_f32 v65, v65, v159
    v_mul_f32 v66, v66, v159
    v_mul_f32 v67, v67, v159
    v_cvt_pk_bf16_f32 v8, v64, v65
    v_cvt_pk_bf16_f32 v9, v66, v67
    buffer_store_dwordx2 v[8:9], v165, s[8:11], 0 offen offset:64
    v_mul_f32 v68, v68, v159
    v_mul_f32 v69, v69, v159
    v_mul_f32 v70, v70, v159
    v_mul_f32 v71, v71, v159
    v_cvt_pk_bf16_f32 v10, v68, v69
    v_cvt_pk_bf16_f32 v11, v70, v71
    buffer_store_dwordx2 v[10:11], v165, s[8:11], 0 offen offset:80
    v_mul_f32 v72, v72, v159
    v_mul_f32 v73, v73, v159
    v_mul_f32 v74, v74, v159
    v_mul_f32 v75, v75, v159
    v_cvt_pk_bf16_f32 v12, v72, v73
    v_cvt_pk_bf16_f32 v13, v74, v75
    buffer_store_dwordx2 v[12:13], v165, s[8:11], 0 offen offset:96
    v_mul_f32 v76, v76, v159
    v_mul_f32 v77, v77, v159
    v_mul_f32 v78, v78, v159
    v_mul_f32 v79, v79, v159
    v_cvt_pk_bf16_f32 v14, v76, v77
    v_cvt_pk_bf16_f32 v15, v78, v79
    buffer_store_dwordx2 v[14:15], v165, s[8:11], 0 offen offset:112
    v_mul_f32 v80, v80, v159
    v_mul_f32 v81, v81, v159
    v_mul_f32 v82, v82, v159
    v_mul_f32 v83, v83, v159
    v_cvt_pk_bf16_f32 v16, v80, v81
    v_cvt_pk_bf16_f32 v17, v82, v83
    buffer_store_dwordx2 v[16:17], v165, s[8:11], 0 offen offset:128
    v_mul_f32 v84, v84, v159
    v_mul_f32 v85, v85, v159
    v_mul_f32 v86, v86, v159
    v_mul_f32 v87, v87, v159
    v_cvt_pk_bf16_f32 v18, v84, v85
    v_cvt_pk_bf16_f32 v19, v86, v87
    buffer_store_dwordx2 v[18:19], v165, s[8:11], 0 offen offset:144
    v_mul_f32 v88, v88, v159
    v_mul_f32 v89, v89, v159
    v_mul_f32 v90, v90, v159
    v_mul_f32 v91, v91, v159
    v_cvt_pk_bf16_f32 v20, v88, v89
    v_cvt_pk_bf16_f32 v21, v90, v91
    buffer_store_dwordx2 v[20:21], v165, s[8:11], 0 offen offset:160
    v_mul_f32 v92, v92, v159
    v_mul_f32 v93, v93, v159
    v_mul_f32 v94, v94, v159
    v_mul_f32 v95, v95, v159
    v_cvt_pk_bf16_f32 v22, v92, v93
    v_cvt_pk_bf16_f32 v23, v94, v95
    buffer_store_dwordx2 v[22:23], v165, s[8:11], 0 offen offset:176
    v_mov_b32 v48, 0
    v_mov_b32 v49, 0
    v_mov_b32 v50, 0
    v_mov_b32 v51, 0
    v_mov_b32 v52, 0
    v_mov_b32 v53, 0
    v_mov_b32 v54, 0
    v_mov_b32 v55, 0
    v_mov_b32 v56, 0
    v_mov_b32 v57, 0
    v_mov_b32 v58, 0
    v_mov_b32 v59, 0
    v_mov_b32 v60, 0
    v_mov_b32 v61, 0
    v_mov_b32 v62, 0
    v_mov_b32 v63, 0
    v_mov_b32 v64, 0
    v_mov_b32 v65, 0
    v_mov_b32 v66, 0
    v_mov_b32 v67, 0
    v_mov_b32 v68, 0
    v_mov_b32 v69, 0
    v_mov_b32 v70, 0
    v_mov_b32 v71, 0
    v_mov_b32 v72, 0
    v_mov_b32 v73, 0
    v_mov_b32 v74, 0
    v_mov_b32 v75, 0
    v_mov_b32 v76, 0
    v_mov_b32 v77, 0
    v_mov_b32 v78, 0
    v_mov_b32 v79, 0
    v_mov_b32 v80, 0
    v_mov_b32 v81, 0
    v_mov_b32 v82, 0
    v_mov_b32 v83, 0
    v_mov_b32 v84, 0
    v_mov_b32 v85, 0
    v_mov_b32 v86, 0
    v_mov_b32 v87, 0
    v_mov_b32 v88, 0
    v_mov_b32 v89, 0
    v_mov_b32 v90, 0
    v_mov_b32 v91, 0
    v_mov_b32 v92, 0
    v_mov_b32 v93, 0
    v_mov_b32 v94, 0
    v_mov_b32 v95, 0
    v_add_u32 v152, s19, v158
    v_add_u32 v153, s20, v158
    s_mul_i32 s27, s17, 12288
    s_waitcnt vmcnt(12)
    ds_read_b128 v[136:139], v152 offset:0
    ds_read_b128 v[140:143], v152 offset:1024
    ds_read_b128 v[144:147], v152 offset:2048
    ds_read_b128 v[148:151], v152 offset:3072
    s_waitcnt lgkmcnt(0)
    v_mfma_f32_32x32x16_bf16 v[0:15], v[136:139], v[96:99], 0
    v_mfma_f32_32x32x16_bf16 v[0:15], v[140:143], v[100:103], v[0:15]
    v_mfma_f32_32x32x16_bf16 v[0:15], v[144:147], v[104:107], v[0:15]
    v_mfma_f32_32x32x16_bf16 v[0:15], v[148:151], v[108:111], v[0:15]
    ds_read_b128 v[136:139], v152 offset:4096
    ds_read_b128 v[140:143], v152 offset:5120
    s_waitcnt lgkmcnt(0)
    v_mfma_f32_32x32x16_bf16 v[0:15], v[136:139], v[112:115], v[0:15]
    v_mfma_f32_32x32x16_bf16 v[0:15], v[140:143], v[116:119], v[0:15]
    s_nop 15
    s_nop 15
    v_max3_f32 v161, v0, v1, v2
    v_max3_f32 v161, v161, v3, v4
    v_max3_f32 v161, v161, v5, v6
    v_max3_f32 v161, v161, v7, v8
    v_max3_f32 v161, v161, v9, v10
    v_max3_f32 v161, v161, v11, v12
    v_max3_f32 v161, v161, v13, v14
    v_max_f32 v161, v161, v15
    v_mov_b32 v159, v161
    s_nop 1
    v_permlane32_swap_b32 v161, v159
    s_nop 1
    v_max_f32 v161, v161, v159
    v_sub_f32 v0, v0, v161
    v_sub_f32 v1, v1, v161
    v_sub_f32 v2, v2, v161
    v_sub_f32 v3, v3, v161
    v_sub_f32 v4, v4, v161
    v_sub_f32 v5, v5, v161
    v_sub_f32 v6, v6, v161
    v_sub_f32 v7, v7, v161
    v_sub_f32 v8, v8, v161
    v_sub_f32 v9, v9, v161
    v_sub_f32 v10, v10, v161
    v_sub_f32 v11, v11, v161
    v_sub_f32 v12, v12, v161
    v_sub_f32 v13, v13, v161
    v_sub_f32 v14, v14, v161
    v_sub_f32 v15, v15, v161
    v_exp_f32 v0, v0
    v_exp_f32 v1, v1
    v_exp_f32 v2, v2
    v_exp_f32 v3, v3
    v_exp_f32 v4, v4
    v_exp_f32 v5, v5
    v_exp_f32 v6, v6
    v_exp_f32 v7, v7
    v_exp_f32 v8, v8
    v_exp_f32 v9, v9
    v_exp_f32 v10, v10
    v_exp_f32 v11, v11
    v_exp_f32 v12, v12
    v_exp_f32 v13, v13
    v_exp_f32 v14, v14
    v_exp_f32 v15, v15
    s_nop 1
    v_add_f32 v155, v0, v1
    v_add_f32 v155, v155, v2
    v_add_f32 v155, v155, v3
    v_add_f32 v155, v155, v4
    v_add_f32 v155, v155, v5
    v_add_f32 v155, v155, v6
    v_add_f32 v155, v155, v7
    v_add_f32 v155, v155, v8
    v_add_f32 v155, v155, v9
    v_add_f32 v155, v155, v10
    v_add_f32 v155, v155, v11
    v_add_f32 v155, v155, v12
    v_add_f32 v155, v155, v13
    v_add_f32 v155, v155, v14
    v_add_f32 v155, v155, v15
    v_cvt_pk_bf16_f32 v120, v0, v1
    v_cvt_pk_bf16_f32 v121, v2, v3
    v_cvt_pk_bf16_f32 v122, v4, v5
    v_cvt_pk_bf16_f32 v123, v6, v7
    v_cvt_pk_bf16_f32 v124, v8, v9
    v_cvt_pk_bf16_f32 v125, v10, v11
    v_cvt_pk_bf16_f32 v126, v12, v13
    v_cvt_pk_bf16_f32 v127, v14, v15
    v_mov_b32 v154, v155
    v_sub_f32 v32, 0, v161
    v_sub_f32 v33, 0, v161
    v_sub_f32 v34, 0, v161
    v_sub_f32 v35, 0, v161
    v_sub_f32 v36, 0, v161
    v_sub_f32 v37, 0, v161
    v_sub_f32 v38, 0, v161
    v_sub_f32 v39, 0, v161
    v_sub_f32 v40, 0, v161
    v_sub_f32 v41, 0, v161
    v_sub_f32 v42, 0, v161
    v_sub_f32 v43, 0, v161
    v_sub_f32 v44, 0, v161
    v_sub_f32 v45, 0, v161
    v_sub_f32 v46, 0, v161
    v_sub_f32 v47, 0, v161
    s_nop 1
    ds_read_b128 v[144:147], v152 offset:12288
    s_waitcnt lgkmcnt(0)
    v_mfma_f32_32x32x16_bf16 v[16:31], v[144:147], v[96:99], v[32:47]
    ds_read_b128 v[148:151], v152 offset:13312
    ds_read_b128 v[136:139], v152 offset:14336
    ds_read_b128 v[140:143], v152 offset:15360
    s_waitcnt lgkmcnt(2)
    v_mfma_f32_32x32x16_bf16 v[16:31], v[148:151], v[100:103], v[16:31]
    ds_read_b128 v[144:147], v152 offset:16384
    s_waitcnt lgkmcnt(2)
    v_mfma_f32_32x32x16_bf16 v[16:31], v[136:139], v[104:107], v[16:31]
    ds_read_b128 v[148:151], v152 offset:17408
    s_waitcnt lgkmcnt(2)
    v_mfma_f32_32x32x16_bf16 v[16:31], v[140:143], v[108:111], v[16:31]
    ds_read_b128 v[136:139], v153 offset:0
    s_waitcnt lgkmcnt(2)
    v_mfma_f32_32x32x16_bf16 v[16:31], v[144:147], v[112:115], v[16:31]
    ds_read_b128 v[140:143], v153 offset:1024
    s_waitcnt lgkmcnt(2)
    v_mfma_f32_32x32x16_bf16 v[16:31], v[148:151], v[116:119], v[16:31]
    ds_read_b128 v[144:147], v153 offset:2048
    s_mov_b32 s18, 17
L_r2:
    s_mov_b32 s29, s19
    s_mov_b32 s19, s20
    s_mov_b32 s20, s21
    s_mov_b32 s21, s29
    v_add_u32 v152, s19, v158
    v_add_u32 v153, s20, v158
    s_add_u32 s29, s21, s37
    s_mov_b32 m0, s29
    s_add_u32 s40, s22, s23
    s_add_u32 s41, s22, s24
    s_add_u32 s42, s22, s25
    s_add_u32 s43, s22, s26
    s_cmp_gt_u32 s34, 36
    s_cselect_b32 s40, 0x40000000, s40
    s_cselect_b32 s41, 0x40000000, s41
    s_cselect_b32 s42, 0x40000000, s42
    s_cselect_b32 s43, 0x40000000, s43
    s_add_u32 s34, s34, 1
    s_add_u32 s22, s22, 49152
    s_cmp_eq_u32 s34, s32
    s_cselect_b32 s29, s33, 0
    s_sub_u32 s22, s22, s29
    s_waitcnt vmcnt(0)
    s_barrier
    s_add_u32 s27, s27, 49152
    s_waitcnt lgkmcnt(2)
    v_mfma_f32_32x32x16_bf16 v[0:15], v[136:139], v[96:99], v[32:47]
    ds_read_b128 v[148:151], v152 offset:3072
    v_exp_f32 v16, v16
    v_exp_f32 v17, v17
    s_waitcnt lgkmcnt(2)
    v_mfma_f32_32x32x16_bf16 v[0:15], v[140:143], v[100:103], v[0:15]
    ds_read_b128 v[136:139], v152 offset:4096
    buffer_load_dwordx4 v157, s[12:15], s40 offen offset:0 lds
    v_exp_f32 v18, v18
    v_exp_f32 v19, v19
    v_cvt_pk_bf16_f32 v128, v16, v17
    s_waitcnt lgkmcnt(2)
    v_mfma_f32_32x32x16_bf16 v[0:15], v[144:147], v[104:107], v[0:15]
    ds_read_b128 v[140:143], v152 offset:5120
    v_exp_f32 v20, v20
    v_exp_f32 v21, v21
    v_add_f32 v155, v16, v18
    s_waitcnt lgkmcnt(2)
    v_mfma_f32_32x32x16_bf16 v[0:15], v[148:151], v[108:111], v[0:15]
    ds_read_b128 v[144:147], v152 offset:24576
    v_add_f32 v156, v17, v19
    v_cvt_pk_bf16_f32 v129, v18, v19
    v_exp_f32 v22, v22
    s_waitcnt lgkmcnt(2)
    v_mfma_f32_32x32x16_bf16 v[0:15], v[136:139], v[112:115], v[0:15]
    ds_read_b128 v[148:151], v152 offset:25600
    buffer_load_dwordx4 v157, s[12:15], s41 offen offset:1024 lds
    v_exp_f32 v23, v23
    v_add_f32 v155, v20, v155
    v_add_f32 v156, v21, v156
    v_cvt_pk_bf16_f32 v130, v20, v21
    s_waitcnt lgkmcnt(2)
    v_mfma_f32_32x32x16_bf16 v[0:15], v[140:143], v[116:119], v[0:15]
    ds_read_b128 v[136:139], v152 offset:26624
    v_exp_f32 v24, v24
    v_exp_f32 v25, v25
    s_waitcnt lgkmcnt(2)
    v_mfma_f32_32x32x16_bf16 v[48:63], v[144:147], v[120:123], v[48:63]
    ds_read_b128 v[140:143], v152 offset:27648
    v_add_f32 v155, v22, v155
    v_add_f32 v156, v23, v156
    v_cvt_pk_bf16_f32 v131, v22, v23
    v_exp_f32 v26, v26
    s_waitcnt lgkmcnt(2)
    v_mfma_f32_32x32x16_bf16 v[48:63], v[148:151], v[124:127], v[48:63]
    ds_read_b128 v[144:147], v152 offset:28672
    buffer_load_dwordx4 v157, s[12:15], s42 offen offset:2048 lds
    v_exp_f32 v27, v27
    v_add_f32 v155, v24, v155
    v_add_f32 v156, v25, v156
    v_cvt_pk_bf16_f32 v132, v24, v25
    s_waitcnt lgkmcnt(2)
    v_mfma_f32_32x32x16_bf16 v[64:79], v[136:139], v[120:123], v[64:79]
    ds_read_b128 v[148:151], v152 offset:29696
    v_exp_f32 v28, v28
    v_exp_f32 v29, v29
    s_waitcnt lgkmcnt(2)
    v_mfma_f32_32x32x16_bf16 v[64:79], v[140:143], v[124:127], v[64:79]
    ds_read_b128 v[136:139], v152 offset:12288
    v_add_f32 v155, v26, v155
    v_add_f32 v156, v27, v156
    v_cvt_pk_bf16_f32 v133, v26, v27
    v_exp_f32 v30, v30
    s_waitcnt lgkmcnt(2)
    v_mfma_f32_32x32x16_bf16 v[80:95], v[144:147], v[120:123], v[80:95]
    ds_read_b128 v[140:143], v152 offset:13312
    buffer_load_dwordx4 v157, s[12:15], s43 offen offset:3072 lds
    v_exp_f32 v31, v31
    v_add_f32 v155, v28, v155
    v_add_f32 v156, v29, v156
    s_waitcnt lgkmcnt(2)
    v_mfma_f32_32x32x16_bf16 v[80:95], v[148:151], v[124:127], v[80:95]
    ds_read_b128 v[144:147], v152 offset:14336
    v_cvt_pk_bf16_f32 v134, v28, v29
    v_add_f32 v155, v30, v155
    v_add_f32 v156, v31, v156
    v_cvt_pk_bf16_f32 v135, v30, v31
    v_add_f32 v155, v155, v156
    v_cmp_nge_f32 vcc, s28, v155
    s_cbranch_vccnz L_slow_15
L_back_16:
    v_add_f32 v154, v154, v155
    s_waitcnt lgkmcnt(2)
    v_mfma_f32_32x32x16_bf16 v[16:31], v[136:139], v[96:99], v[32:47]
    ds_read_b128 v[148:151], v152 offset:15360
    v_exp_f32 v0, v0
    v_exp_f32 v1, v1
    s_waitcnt lgkmcnt(2)
    v_mfma_f32_32x32x16_bf16 v[16:31], v[140:143], v[100:103], v[16:31]
    ds_read_b128 v[136:139], v152 offset:16384
    v_exp_f32 v2, v2
    v_exp_f32 v3, v3
    v_cvt_pk_bf16_f32 v120, v0, v1
    s_waitcnt lgkmcnt(2)
    v_mfma_f32_32x32x16_bf16 v[16:31], v[144:147], v[104:107], v[16:31]
    ds_read_b128 v[140:143], v152 offset:17408
    v_exp_f32 v4, v4
    v_exp_f32 v5, v5
    v_add_f32 v155, v0, v2
    s_waitcnt lgkmcnt(2)
    v_mfma_f32_32x32x16_bf16 v[16:31], v[148:151], v[108:111], v[16:31]
    ds_read_b128 v[144:147], v152 offset:36864
    v_add_f32 v156, v1, v3
    v_cvt_pk_bf16_f32 v121, v2, v3
    v_exp_f32 v6, v6
    s_waitcnt lgkmcnt(2)
    v_mfma_f32_32x32x16_bf16 v[16:31], v[136:139], v[112:115], v[16:31]
    ds_read_b128 v[148:151], v152 offset:37888
    v_exp_f32 v7, v7
    v_add_f32 v155, v4, v155
    v_add_f32 v156, v5, v156
    v_cvt_pk_bf16_f32 v122, v4, v5
    s_waitcnt lgkmcnt(2)
    v_mfma_f32_32x32x16_bf16 v[16:31], v[140:143], v[116:119], v[16:31]
    ds_read_b128 v[136:139], v152 offset:38912
    v_exp_f32 v8, v8
    v_exp_f32 v9, v9
    s_waitcnt lgkmcnt(2)
    v_mfma_f32_32x32x16_bf16 v[48:63], v[144:147], v[128:131], v[48:63]
    ds_read_b128 v[140:143], v152 offset:39936
    v_add_f32 v155, v6, v155
    v_add_f32 v156, v7, v156
    v_cvt_pk_bf16_f32 v123, v6, v7
    v_exp_f32 v10, v10
    s_waitcnt lgkmcnt(2)
    v_mfma_f32_32x32x16_bf16 v[48:63], v[148:151], v[132:135], v[48:63]
    ds_read_b128 v[144:147], v152 offset:40960
    v_exp_f32 v11, v11
    v_add_f32 v155, v8, v155
    v_add_f32 v156, v9, v156
    v_cvt_pk_bf16_f32 v124, v8, v9
    s_waitcnt lgkmcnt(2)
    v_mfma_f32_32x32x16_bf16 v[64:79], v[136:139], v[128:131], v[64:79]
    ds_read_b128 v[148:151], v152 offset:41984
    v_exp_f32 v12, v12
    v_exp_f32 v13, v13
    s_waitcnt lgkmcnt(2)
    v_mfma_f32_32x32x16_bf16 v[64:79], v[140:143], v[132:135], v[64:79]
    ds_read_b128 v[136:139], v153 offset:0
    v_add_f32 v155, v10, v155
    v_add_f32 v156, v11, v156
    v_cvt_pk_bf16_f32 v125, v10, v11
    v_exp_f32 v14, v14
    s_waitcnt lgkmcnt(2)
    v_mfma_f32_32x32x16_bf16 v[80:95], v[144:147], v[128:131], v[80:95]
    ds_read_b128 v[140:143], v153 offset:1024
    v_exp_f32 v15, v15
    v_add_f32 v155, v12, v155
    v_add_f32 v156, v13, v156
    s_waitcnt lgkmcnt(2)
    v_mfma_f32_32x32x16_bf16 v[80:95], v[148:151], v[132:135], v[80:95]
    ds_read_b128 v[144:147], v153 offset:2048
    v_cvt_pk_bf16_f32 v126, v12, v13
    v_add_f32 v155, v14, v155
    v_add_f32 v156, v15, v156
    v_cvt_pk_bf16_f32 v127, v14, v15
    v_add_f32 v155, v155, v156
    v_cmp_nge_f32 vcc, s28, v155
    s_cbranch_vccnz L_slow_17
L_back_18:
    v_add_f32 v154, v154, v155
    s_sub_u32 s18, s18, 1
    s_cmp_lg_u32 s18, 0
    s_cbranch_scc1 L_r2
    s_waitcnt lgkmcnt(0)
    s_waitcnt vmcnt(0)
    s_barrier
    s_mov_b32 s29, s19
    s_mov_b32 s19, s20
    s_mov_b32 s20, s21
    s_mov_b32 s21, s29
    v_add_u32 v152, s19, v158
    v_add_u32 v153, s20, v158
    s_cmp_gt_u32 s34, 36
    s_cbranch_scc1 L_nodma_19
    s_add_u32 s29, s21, s37
    s_mov_b32 m0, s29
    s_add_u32 s30, s22, s23
    buffer_load_dwordx4 v157, s[12:15], s30 offen offset:0 lds
    s_add_u32 s30, s22, s24
    buffer_load_dwordx4 v157, s[12:15], s30 offen offset:1024 lds
    s_add_u32 s30, s22, s25
    buffer_load_dwordx4 v157, s[12:15], s30 offen offset:2048 lds
    s_add_u32 s30, s22, s26
    buffer_load_dwordx4 v157, s[12:15], s30 offen offset:3072 lds
L_nodma_19:
    s_add_u32 s34, s34, 1
    s_add_u32 s22, s22, 49152
    s_cmp_eq_u32 s34, s32
    s_cselect_b32 s29, s33, 0
    s_sub_u32 s22, s22, s29
    ds_read_b128 v[144:147], v152 offset:24576
    s_waitcnt lgkmcnt(0)
    v_mfma_f32_32x32x16_bf16 v[48:63], v[144:147], v[120:123], v[48:63]
    ds_read_b128 v[148:151], v152 offset:25600
    ds_read_b128 v[136:139], v152 offset:26624
    ds_read_b128 v[140:143], v152 offset:27648
    v_exp_f32 v16, v16
    v_exp_f32 v17, v17
    v_exp_f32 v18, v18
    v_exp_f32 v19, v19
    v_cvt_pk_bf16_f32 v128, v16, v17
    s_waitcnt lgkmcnt(2)
    v_mfma_f32_32x32x16_bf16 v[48:63], v[148:151], v[124:127], v[48:63]
    ds_read_b128 v[144:147], v152 offset:28672
    v_exp_f32 v20, v20
    v_exp_f32 v21, v21
    v_add_f32 v155, v16, v18
    v_add_f32 v156, v17, v19
    v_cvt_pk_bf16_f32 v129, v18, v19
    v_exp_f32 v22, v22
    s_waitcnt lgkmcnt(2)
    v_mfma_f32_32x32x16_bf16 v[64:79], v[136:139], v[120:123], v[64:79]
    ds_read_b128 v[148:151], v152 offset:29696
    v_exp_f32 v23, v23
    v_add_f32 v155, v20, v155
    v_add_f32 v156, v21, v156
    v_cvt_pk_bf16_f32 v130, v20, v21
    v_exp_f32 v24, v24
    v_exp_f32 v25, v25
    s_waitcnt lgkmcnt(2)
    v_mfma_f32_32x32x16_bf16 v[64:79], v[140:143], v[124:127], v[64:79]
    v_add_f32 v155, v22, v155
    v_add_f32 v156, v23, v156
    v_cvt_pk_bf16_f32 v131, v22, v23
    v_exp_f32 v26, v26
    v_exp_f32 v27, v27
    v_add_f32 v155, v24, v155
    v_add_f32 v156, v25, v156
    v_cvt_pk_bf16_f32 v132, v24, v25
    s_waitcnt lgkmcnt(1)
    v_mfma_f32_32x32x16_bf16 v[80:95], v[144:147], v[120:123], v[80:95]
    v_exp_f32 v28, v28
    v_exp_f32 v29, v29
    v_add_f32 v155, v26, v155
    v_add_f32 v156, v27, v156
    v_cvt_pk_bf16_f32 v133, v26, v27
    v_exp_f32 v30, v30
    s_waitcnt lgkmcnt(0)
    v_mfma_f32_32x32x16_bf16 v[80:95], v[148:151], v[124:127], v[80:95]
    v_exp_f32 v31, v31
    v_add_f32 v155, v28, v155
    v_add_f32 v156, v29, v156
    v_cvt_pk_bf16_f32 v134, v28, v29
    v_add_f32 v155, v30, v155
    v_add_f32 v156, v31, v156
    v_cvt_pk_bf16_f32 v135, v30, v31
    v_add_f32 v155, v155, v156
    v_cmp_nge_f32 vcc, s28, v155
    s_cbranch_vccnz L_slow_20
L_back_21:
    v_add_f32 v154, v154, v155
    s_nop 1
    ds_read_b128 v[144:147], v152 offset:36864
    s_waitcnt lgkmcnt(0)
    v_mfma_f32_32x32x16_bf16 v[48:63], v[144:147], v[128:131], v[48:63]
    ds_read_b128 v[148:151], v152 offset:37888
    ds_read_b128 v[136:139], v152 offset:38912
    ds_read_b128 v[140:143], v152 offset:39936
    s_waitcnt lgkmcnt(2)
    v_mfma_f32_32x32x16_bf16 v[48:63], v[148:151], v[132:135], v[48:63]
    ds_read_b128 v[144:147], v152 offset:40960
    s_waitcnt lgkmcnt(2)
    v_mfma_f32_32x32x16_bf16 v[64:79], v[136:139], v[128:131], v[64:79]
    ds_read_b128 v[148:151], v152 offset:41984
    s_waitcnt lgkmcnt(2)
    v_mfma_f32_32x32x16_bf16 v[64:79], v[140:143], v[132:135], v[64:79]
    s_waitcnt lgkmcnt(1)
    v_mfma_f32_32x32x16_bf16 v[80:95], v[144:147], v[128:131], v[80:95]
    s_waitcnt lgkmcnt(0)
    v_mfma_f32_32x32x16_bf16 v[80:95], v[148:151], v[132:135], v[80:95]
    s_nop 15
    s_nop 7
    s_lshr_b32 s29, s16, 1
    s_mul_i32 s29, s29, 13312
    s_add_u32 s29, s29, 49152
    v_add_u32 v164, s29, v157
    s_cmp_eq_u32 s17, 0
    s_cbranch_scc1 L_merge_wait
    ds_write_b128 v164, v[48:51] offset:0
    ds_write_b128 v164, v[52:55] offset:1024
    ds_write_b128 v164, v[56:59] offset:2048
    ds_write_b128 v164, v[60:63] offset:3072
    ds_write_b128 v164, v[64:67] offset:4096
    ds_write_b128 v164, v[68:71] offset:5120
    ds_write_b128 v164, v[72:75] offset:6144
    ds_write_b128 v164, v[76:79] offset:7168
    ds_write_b128 v164, v[80:83] offset:8192
    ds_write_b128 v164, v[84:87] offset:9216
    ds_write_b128 v164, v[88:91] offset:10240
    ds_write_b128 v164, v[92:95] offset:11264
    v_lshrrev_b32 v163, 2, v157
    v_add_u32 v163, s29, v163
    ds_write_b32 v163, v32 offset:12288
    ds_write_b32 v163, v154 offset:12544
    s_waitcnt lgkmcnt(0)
L_merge_wait:
    s_barrier
    s_cmp_lg_u32 s17, 0
    s_cbranch_scc1 L_main_end
    v_lshrrev_b32 v163, 2, v157
    v_add_u32 v163, s29, v163
    ds_read_b32 v160, v163 offset:12288
    ds_read_b32 v161, v163 offset:12544
    s_waitcnt lgkmcnt(0)
    v_min_f32 v162, v32, v160
    v_sub_f32 v159, v162, v32
    v_sub_f32 v160, v162, v160
    v_exp_f32 v159, v159
    v_exp_f32 v160, v160
    s_nop 1
    v_mul_f32 v154, v154, v159
    v_fma_f32 v154, v161, v160, v154
    ds_read_b128 v[0:3], v164 offset:0
    s_waitcnt lgkmcnt(0)
    v_mul_f32 v48, v48, v159
    v_fma_f32 v48, v0, v160, v48
    v_mul_f32 v49, v49, v159
    v_fma_f32 v49, v1, v160, v49
    v_mul_f32 v50, v50, v159
    v_fma_f32 v50, v2, v160, v50
    v_mul_f32 v51, v51, v159
    v_fma_f32 v51, v3, v160, v51
    ds_read_b128 v[4:7], v164 offset:1024
    s_waitcnt lgkmcnt(0)
    v_mul_f32 v52, v52, v159
    v_fma_f32 v52, v4, v160, v52
    v_mul_f32 v53, v53, v159
    v_fma_f32 v53, v5, v160, v53
    v_mul_f32 v54, v54, v159
    v_fma_f32 v54, v6, v160, v54
    v_mul_f32 v55, v55, v159
    v_fma_f32 v55, v7, v160, v55
    ds_read_b128 v[8:11], v164 offset:2048
    s_waitcnt lgkmcnt(0)
    v_mul_f32 v56, v56, v159
    v_fma_f32 v56, v8, v160, v56
    v_mul_f32 v57, v57, v159
    v_fma_f32 v57, v9, v160, v57
    v_mul_f32 v58, v58, v159
    v_fma_f32 v58, v10, v160, v58
    v_mul_f32 v59, v59, v159
    v_fma_f32 v59, v11, v160, v59
    ds_read_b128 v[12:15], v164 offset:3072
    s_waitcnt lgkmcnt(0)
    v_mul_f32 v60, v60, v159
    v_fma_f32 v60, v12, v160, v60
    v_mul_f32 v61, v61, v159
    v_fma_f32 v61, v13, v160, v61
    v_mul_f32 v62, v62, v159
    v_fma_f32 v62, v14, v160, v62
    v_mul_f32 v63, v63, v159
    v_fma_f32 v63, v15, v160, v63
    ds_read_b128 v[0:3], v164 offset:4096
    s_waitcnt lgkmcnt(0)
    v_mul_f32 v64, v64, v159
    v_fma_f32 v64, v0, v160, v64
    v_mul_f32 v65, v65, v159
    v_fma_f32 v65, v1, v160, v65
    v_mul_f32 v66, v66, v159
    v_fma_f32 v66, v2, v160, v66
    v_mul_f32 v67, v67, v159
    v_fma_f32 v67, v3, v160, v67
    ds_read_b128 v[4:7], v164 offset:5120
    s_waitcnt lgkmcnt(0)
    v_mul_f32 v68, v68, v159
    v_fma_f32 v68, v4, v160, v68
    v_mul_f32 v69, v69, v159
    v_fma_f32 v69, v5, v160, v69
    v_mul_f32 v70, v70, v159
    v_fma_f32 v70, v6, v160, v70
    v_mul_f32 v71, v71, v159
    v_fma_f32 v71, v7, v160, v71
    ds_read_b128 v[8:11], v164 offset:6144
    s_waitcnt lgkmcnt(0)
    v_mul_f32 v72, v72, v159
    v_fma_f32 v72, v8, v160, v72
    v_mul_f32 v73, v73, v159
    v_fma_f32 v73, v9, v160, v73
    v_mul_f32 v74, v74, v159
    v_fma_f32 v74, v10, v160, v74
    v_mul_f32 v75, v75, v159
    v_fma_f32 v75, v11, v160, v75
    ds_read_b128 v[12:15], v164 offset:7168
    s_waitcnt lgkmcnt(0)
    v_mul_f32 v76, v76, v159
    v_fma_f32 v76, v12, v160, v76
    v_mul_f32 v77, v77, v159
    v_fma_f32 v77, v13, v160, v77
    v_mul_f32 v78, v78, v159
    v_fma_f32 v78, v14, v160, v78
    v_mul_f32 v79, v79, v159
    v_fma_f32 v79, v15, v160, v79
    ds_read_b128 v[0:3], v164 offset:8192
    s_waitcnt lgkmcnt(0)
    v_mul_f32 v80, v80, v159
    v_fma_f32 v80, v0, v160, v80
    v_mul_f32 v81, v81, v159
    v_fma_f32 v81, v1, v160, v81
    v_mul_f32 v82, v82, v159
    v_fma_f32 v82, v2, v160, v82
    v_mul_f32 v83, v83, v159
    v_fma_f32 v83, v3, v160, v83
    ds_read_b128 v[4:7], v164 offset:9216
    s_waitcnt lgkmcnt(0)
    v_mul_f32 v84, v84, v159
    v_fma_f32 v84, v4, v160, v84
    v_mul_f32 v85, v85, v159
    v_fma_f32 v85, v5, v160, v85
    v_mul_f32 v86, v86, v159
    v_fma_f32 v86, v6, v160, v86
    v_mul_f32 v87, v87, v159
    v_fma_f32 v87, v7, v160, v87
    ds_read_b128 v[8:11], v164 offset:10240
    s_waitcnt lgkmcnt(0)
    v_mul_f32 v88, v88, v159
    v_fma_f32 v88, v8, v160, v88
    v_mul_f32 v89, v89, v159
    v_fma_f32 v89, v9, v160, v89
    v_mul_f32 v90, v90, v159
    v_fma_f32 v90, v10, v160, v90
    v_mul_f32 v91, v91, v159
    v_fma_f32 v91, v11, v160, v91
    ds_read_b128 v[12:15], v164 offset:11264
    s_waitcnt lgkmcnt(0)
    v_mul_f32 v92, v92, v159
    v_fma_f32 v92, v12, v160, v92
    v_mul_f32 v93, v93, v159
    v_fma_f32 v93, v13, v160, v93
    v_mul_f32 v94, v94, v159
    v_fma_f32 v94, v14, v160, v94
    v_mul_f32 v95, v95, v159
    v_fma_f32 v95, v15, v160, v95
    v_mov_b32 v159, v154
    v_mov_b32 v160, v154
    s_nop 1
    v_permlane32_swap_b32 v159, v160
    s_nop 1
    v_add_f32 v159, v159, v160
    v_rcp_f32 v159, v159
    v_lshrrev_b32 v160, 4, v157
    v_and_b32 v161, 31, v160
    v_lshrrev_b32 v160, 5, v160
    v_mul_u32_u24 v161, 192, v161
    v_lshl_add_u32 v161, v160, 3, v161
    v_add_u32 v165, s36, v161
    v_mul_f32 v48, v48, v159
    v_mul_f32 v49, v49, v159
    v_mul_f32 v50, v50, v159
    v_mul_f32 v51, v51, v159
    v_cvt_pk_bf16_f32 v0, v48, v49
    v_cvt_pk_bf16_f32 v1, v50, v51
    buffer_store_dwordx2 v[0:1], v165, s[8:11], 0 offen offset:0
    v_mul_f32 v52, v52, v159
    v_mul_f32 v53, v53, v159
    v_mul_f32 v54, v54, v159
    v_mul_f32 v55, v55, v159
    v_cvt_pk_bf16_f32 v2, v52, v53
    v_cvt_pk_bf16_f32 v3, v54, v55
    buffer_store_dwordx2 v[2:3], v165, s[8:11], 0 offen offset:16
    v_mul_f32 v56, v56, v159
    v_mul_f32 v57, v57, v159
    v_mul_f32 v58, v58, v159
    v_mul_f32 v59, v59, v159
    v_cvt_pk_bf16_f32 v4, v56, v57
    v_cvt_pk_bf16_f32 v5, v58, v59
    buffer_store_dwordx2 v[4:5], v165, s[8:11], 0 offen offset:32
    v_mul_f32 v60, v60, v159
    v_mul_f32 v61, v61, v159
    v_mul_f32 v62, v62, v159
    v_mul_f32 v63, v63, v159
    v_cvt_pk_bf16_f32 v6, v60, v61
    v_cvt_pk_bf16_f32 v7, v62, v63
    buffer_store_dwordx2 v[6:7], v165, s[8:11], 0 offen offset:48
    v_mul_f32 v64, v64, v159
    v_mul_f32 v65, v65, v159
    v_mul_f32 v66, v66, v159
    v_mul_f32 v67, v67, v159
    v_cvt_pk_bf16_f32 v8, v64, v65
    v_cvt_pk_bf16_f32 v9, v66, v67
    buffer_store_dwordx2 v[8:9], v165, s[8:11], 0 offen offset:64
    v_mul_f32 v68, v68, v159
    v_mul_f32 v69, v69, v159
    v_mul_f32 v70, v70, v159
    v_mul_f32 v71, v71, v159
    v_cvt_pk_bf16_f32 v10, v68, v69
    v_cvt_pk_bf16_f32 v11, v70, v71
    buffer_store_dwordx2 v[10:11], v165, s[8:11], 0 offen offset:80
    v_mul_f32 v72, v72, v159
    v_mul_f32 v73, v73, v159
    v_mul_f32 v74, v74, v159
    v_mul_f32 v75, v75, v159
    v_cvt_pk_bf16_f32 v12, v72, v73
    v_cvt_pk_bf16_f32 v13, v74, v75
    buffer_store_dwordx2 v[12:13], v165, s[8:11], 0 offen offset:96
    v_mul_f32 v76, v76, v159
    v_mul_f32 v77, v77, v159
    v_mul_f32 v78, v78, v159
    v_mul_f32 v79, v79, v159
    v_cvt_pk_bf16_f32 v14, v76, v77
    v_cvt_pk_bf16_f32 v15, v78, v79
    buffer_store_dwordx2 v[14:15], v165, s[8:11], 0 offen offset:112
    v_mul_f32 v80, v80, v159
    v_mul_f32 v81, v81, v159
    v_mul_f32 v82, v82, v159
    v_mul_f32 v83, v83, v159
    v_cvt_pk_bf16_f32 v16, v80, v81
    v_cvt_pk_bf16_f32 v17, v82, v83
    buffer_store_dwordx2 v[16:17], v165, s[8:11], 0 offen offset:128
    v_mul_f32 v84, v84, v159
    v_mul_f32 v85, v85, v159
    v_mul_f32 v86, v86, v159
    v_mul_f32 v87, v87, v159
    v_cvt_pk_bf16_f32 v18, v84, v85
    v_cvt_pk_bf16_f32 v19, v86, v87
    buffer_store_dwordx2 v[18:19], v165, s[8:11], 0 offen offset:144
    v_mul_f32 v88, v88, v159
    v_mul_f32 v89, v89, v159
    v_mul_f32 v90, v90, v159
    v_mul_f32 v91, v91, v159
    v_cvt_pk_bf16_f32 v20, v88, v89
    v_cvt_pk_bf16_f32 v21, v90, v91
    buffer_store_dwordx2 v[20:21], v165, s[8:11], 0 offen offset:160
    v_mul_f32 v92, v92, v159
    v_mul_f32 v93, v93, v159
    v_mul_f32 v94, v94, v159
    v_mul_f32 v95, v95, v159
    v_cvt_pk_bf16_f32 v22, v92, v93
    v_cvt_pk_bf16_f32 v23, v94, v95
    buffer_store_dwordx2 v[22:23], v165, s[8:11], 0 offen offset:176
L_main_end:
    s_endpgm
L_slow_1:
    s_mov_b32 s38, 12288
    v_mov_b32 v160, v32
    s_nop 7
    buffer_load_dwordx4 v[32:35], v157, s[12:15], s38 offen offset:0
    buffer_load_dwordx4 v[36:39], v157, s[12:15], s38 offen offset:1024
    buffer_load_dwordx4 v[40:43], v157, s[12:15], s38 offen offset:2048
    s_add_u32 s38, s38, 3072
    buffer_load_dwordx4 v[44:47], v157, s[12:15], s38 offen offset:0
    buffer_load_dwordx4 v[128:131], v157, s[12:15], s38 offen offset:1024
    buffer_load_dwordx4 v[132:135], v157, s[12:15], s38 offen offset:2048
    s_waitcnt vmcnt(0)
    v_mfma_f32_32x32x16_bf16 v[16:31], v[32:35], v[96:99], 0
    v_mfma_f32_32x32x16_bf16 v[16:31], v[36:39], v[100:103], v[16:31]
    v_mfma_f32_32x32x16_bf16 v[16:31], v[40:43], v[104:107], v[16:31]
    v_mfma_f32_32x32x16_bf16 v[16:31], v[44:47], v[108:111], v[16:31]
    v_mfma_f32_32x32x16_bf16 v[16:31], v[128:131], v[112:115], v[16:31]
    v_mfma_f32_32x32x16_bf16 v[16:31], v[132:135], v[116:119], v[16:31]
    s_nop 15
    s_nop 15
    v_max3_f32 v161, v16, v17, v18
    v_max3_f32 v161, v161, v19, v20
    v_max3_f32 v161, v161, v21, v22
    v_max3_f32 v161, v161, v23, v24
    v_max3_f32 v161, v161, v25, v26
    v_max3_f32 v161, v161, v27, v28
    v_max3_f32 v161, v161, v29, v30
    v_max_f32 v161, v161, v31
    v_mov_b32 v159, v161
    s_nop 1
    v_permlane32_swap_b32 v161, v159
    s_nop 1
    v_max_f32 v161, v161, v159
    v_max_f32 v161, v161, -v160
    v_sub_f32 v162, -v160, v161
    v_exp_f32 v163, v162
    s_nop 1
    v_mul_f32 v48, v48, v163
    v_mul_f32 v49, v49, v163
    v_mul_f32 v50, v50, v163
    v_mul_f32 v51, v51, v163
    v_mul_f32 v52, v52, v163
    v_mul_f32 v53, v53, v163
    v_mul_f32 v54, v54, v163
    v_mul_f32 v55, v55, v163
    v_mul_f32 v56, v56, v163
    v_mul_f32 v57, v57, v163
    v_mul_f32 v58, v58, v163
    v_mul_f32 v59, v59, v163
    v_mul_f32 v60, v60, v163
    v_mul_f32 v61, v61, v163
    v_mul_f32 v62, v62, v163
    v_mul_f32 v63, v63, v163
    v_mul_f32 v64, v64, v163
    v_mul_f32 v65, v65, v163
    v_mul_f32 v66, v66, v163
    v_mul_f32 v67, v67, v163
    v_mul_f32 v68, v68, v163
    v_mul_f32 v69, v69, v163
    v_mul_f32 v70, v70, v163
    v_mul_f32 v71, v71, v163
    v_mul_f32 v72, v72, v163
    v_mul_f32 v73, v73, v163
    v_mul_f32 v74, v74, v163
    v_mul_f32 v75, v75, v163
    v_mul_f32 v76, v76, v163
    v_mul_f32 v77, v77, v163
    v_mul_f32 v78, v78, v163
    v_mul_f32 v79, v79, v163
    v_mul_f32 v80, v80, v163
    v_mul_f32 v81, v81, v163
    v_mul_f32 v82, v82, v163
    v_mul_f32 v83, v83, v163
    v_mul_f32 v84, v84, v163
    v_mul_f32 v85, v85, v163
    v_mul_f32 v86, v86, v163
    v_mul_f32 v87, v87, v163
    v_mul_f32 v88, v88, v163
    v_mul_f32 v89, v89, v163
    v_mul_f32 v90, v90, v163
    v_mul_f32 v91, v91, v163
    v_mul_f32 v92, v92, v163
    v_mul_f32 v93, v93, v163
    v_mul_f32 v94, v94, v163
    v_mul_f32 v95, v95, v163
    v_mul_f32 v154, v154, v163
    v_add_f32 v0, v0, v162
    v_add_f32 v1, v1, v162
    v_add_f32 v2, v2, v162
    v_add_f32 v3, v3, v162
    v_add_f32 v4, v4, v162
    v_add_f32 v5, v5, v162
    v_add_f32 v6, v6, v162
    v_add_f32 v7, v7, v162
    v_add_f32 v8, v8, v162
    v_add_f32 v9, v9, v162
    v_add_f32 v10, v10, v162
    v_add_f32 v11, v11, v162
    v_add_f32 v12, v12, v162
    v_add_f32 v13, v13, v162
    v_add_f32 v14, v14, v162
    v_add_f32 v15, v15, v162
    v_sub_f32 v16, v16, v161
    v_sub_f32 v17, v17, v161
    v_sub_f32 v18, v18, v161
    v_sub_f32 v19, v19, v161
    v_sub_f32 v20, v20, v161
    v_sub_f32 v21, v21, v161
    v_sub_f32 v22, v22, v161
    v_sub_f32 v23, v23, v161
    v_sub_f32 v24, v24, v161
    v_sub_f32 v25, v25, v161
    v_sub_f32 v26, v26, v161
    v_sub_f32 v27, v27, v161
    v_sub_f32 v28, v28, v161
    v_sub_f32 v29, v29, v161
    v_sub_f32 v30, v30, v161
    v_sub_f32 v31, v31, v161
    v_exp_f32 v16, v16
    v_exp_f32 v17, v17
    v_exp_f32 v18, v18
    v_exp_f32 v19, v19
    v_exp_f32 v20, v20
    v_exp_f32 v21, v21
    v_exp_f32 v22, v22
    v_exp_f32 v23, v23
    v_exp_f32 v24, v24
    v_exp_f32 v25, v25
    v_exp_f32 v26, v26
    v_exp_f32 v27, v27
    v_exp_f32 v28, v28
    v_exp_f32 v29, v29
    v_exp_f32 v30, v30
    v_exp_f32 v31, v31
    s_nop 1
    v_add_f32 v155, v16, v17
    v_add_f32 v155, v155, v18
    v_add_f32 v155, v155, v19
    v_add_f32 v155, v155, v20
    v_add_f32 v155, v155, v21
    v_add_f32 v155, v155, v22
    v_add_f32 v155, v155, v23
    v_add_f32 v155, v155, v24
    v_add_f32 v155, v155, v25
    v_add_f32 v155, v155, v26
    v_add_f32 v155, v155, v27
    v_add_f32 v155, v155, v28
    v_add_f32 v155, v155, v29
    v_add_f32 v155, v155, v30
    v_add_f32 v155, v155, v31
    v_cvt_pk_bf16_f32 v128, v16, v17
    v_cvt_pk_bf16_f32 v129, v18, v19
    v_cvt_pk_bf16_f32 v130, v20, v21
    v_cvt_pk_bf16_f32 v131, v22, v23
    v_cvt_pk_bf16_f32 v132, v24, v25
    v_cvt_pk_bf16_f32 v133, v26, v27
    v_cvt_pk_bf16_f32 v134, v28, v29
    v_cvt_pk_bf16_f32 v135, v30, v31
    v_sub_f32 v32, 0, v161
    v_sub_f32 v33, 0, v161
    v_sub_f32 v34, 0, v161
    v_sub_f32 v35, 0, v161
    v_sub_f32 v36, 0, v161
    v_sub_f32 v37, 0, v161
    v_sub_f32 v38, 0, v161
    v_sub_f32 v39, 0, v161
    v_sub_f32 v40, 0, v161
    v_sub_f32 v41, 0, v161
    v_sub_f32 v42, 0, v161
    v_sub_f32 v43, 0, v161
    v_sub_f32 v44, 0, v161
    v_sub_f32 v45, 0, v161
    v_sub_f32 v46, 0, v161
    v_sub_f32 v47, 0, v161
    s_nop 1
    s_branch L_back_2
L_slow_3:
    s_mov_b32 s38, 24576
    v_mov_b32 v160, v32
    s_nop 7
    buffer_load_dwordx4 v[32:35], v157, s[12:15], s38 offen offset:0
    buffer_load_dwordx4 v[36:39], v157, s[12:15], s38 offen offset:1024
    buffer_load_dwordx4 v[40:43], v157, s[12:15], s38 offen offset:2048
    s_add_u32 s38, s38, 3072
    buffer_load_dwordx4 v[44:47], v157, s[12:15], s38 offen offset:0
    buffer_load_dwordx4 v[120:123], v157, s[12:15], s38 offen offset:1024
    buffer_load_dwordx4 v[124:127], v157, s[12:15], s38 offen offset:2048
    s_waitcnt vmcnt(0)
    v_mfma_f32_32x32x16_bf16 v[0:15], v[32:35], v[96:99], 0
    v_mfma_f32_32x32x16_bf16 v[0:15], v[36:39], v[100:103], v[0:15]
    v_mfma_f32_32x32x16_bf16 v[0:15], v[40:43], v[104:107], v[0:15]
    v_mfma_f32_32x32x16_bf16 v[0:15], v[44:47], v[108:111], v[0:15]
    v_mfma_f32_32x32x16_bf16 v[0:15], v[120:123], v[112:115], v[0:15]
    v_mfma_f32_32x32x16_bf16 v[0:15], v[124:127], v[116:119], v[0:15]
    s_nop 15
    s_nop 15
    v_max3_f32 v161, v0, v1, v2
    v_max3_f32 v161, v161, v3, v4
    v_max3_f32 v161, v161, v5, v6
    v_max3_f32 v161, v161, v7, v8
    v_max3_f32 v161, v161, v9, v10
    v_max3_f32 v161, v161, v11, v12
    v_max3_f32 v161, v161, v13, v14
    v_max_f32 v161, v161, v15
    v_mov_b32 v159, v161
    s_nop 1
    v_permlane32_swap_b32 v161, v159
    s_nop 1
    v_max_f32 v161, v161, v159
    v_max_f32 v161, v161, -v160
    v_sub_f32 v162, -v160, v161
    v_exp_f32 v163, v162
    s_nop 1
    v_mul_f32 v48, v48, v163
    v_mul_f32 v49, v49, v163
    v_mul_f32 v50, v50, v163
    v_mul_f32 v51, v51, v163
    v_mul_f32 v52, v52, v163
    v_mul_f32 v53, v53, v163
    v_mul_f32 v54, v54, v163
    v_mul_f32 v55, v55, v163
    v_mul_f32 v56, v56, v163
    v_mul_f32 v57, v57, v163
    v_mul_f32 v58, v58, v163
    v_mul_f32 v59, v59, v163
    v_mul_f32 v60, v60, v163
    v_mul_f32 v61, v61, v163
    v_mul_f32 v62, v62, v163
    v_mul_f32 v63, v63, v163
    v_mul_f32 v64, v64, v163
    v_mul_f32 v65, v65, v163
    v_mul_f32 v66, v66, v163
    v_mul_f32 v67, v67, v163
    v_mul_f32 v68, v68, v163
    v_mul_f32 v69, v69, v163
    v_mul_f32 v70, v70, v163
    v_mul_f32 v71, v71, v163
    v_mul_f32 v72, v72, v163
    v_mul_f32 v73, v73, v163
    v_mul_f32 v74, v74, v163
    v_mul_f32 v75, v75, v163
    v_mul_f32 v76, v76, v163
    v_mul_f32 v77, v77, v163
    v_mul_f32 v78, v78, v163
    v_mul_f32 v79, v79, v163
    v_mul_f32 v80, v80, v163
    v_mul_f32 v81, v81, v163
    v_mul_f32 v82, v82, v163
    v_mul_f32 v83, v83, v163
    v_mul_f32 v84, v84, v163
    v_mul_f32 v85, v85, v163
    v_mul_f32 v86, v86, v163
    v_mul_f32 v87, v87, v163
    v_mul_f32 v88, v88, v163
    v_mul_f32 v89, v89, v163
    v_mul_f32 v90, v90, v163
    v_mul_f32 v91, v91, v163
    v_mul_f32 v92, v92, v163
    v_mul_f32 v93, v93, v163
    v_mul_f32 v94, v94, v163
    v_mul_f32 v95, v95, v163
    v_mul_f32 v154, v154, v163
    v_add_f32 v16, v16, v162
    v_add_f32 v17, v17, v162
    v_add_f32 v18, v18, v162
    v_add_f32 v19, v19, v162
    v_add_f32 v20, v20, v162
    v_add_f32 v21, v21, v162
    v_add_f32 v22, v22, v162
    v_add_f32 v23, v23, v162
    v_add_f32 v24, v24, v162
    v_add_f32 v25, v25, v162
    v_add_f32 v26, v26, v162
    v_add_f32 v27, v27, v162
    v_add_f32 v28, v28, v162
    v_add_f32 v29, v29, v162
    v_add_f32 v30, v30, v162
    v_add_f32 v31, v31, v162
    v_sub_f32 v0, v0, v161
    v_sub_f32 v1, v1, v161
    v_sub_f32 v2, v2, v161
    v_sub_f32 v3, v3, v161
    v_sub_f32 v4, v4, v161
    v_sub_f32 v5, v5, v161
    v_sub_f32 v6, v6, v161
    v_sub_f32 v7, v7, v161
    v_sub_f32 v8, v8, v161
    v_sub_f32 v9, v9, v161
    v_sub_f32 v10, v10, v161
    v_sub_f32 v11, v11, v161
    v_sub_f32 v12, v12, v161
    v_sub_f32 v13, v13, v161
    v_sub_f32 v14, v14, v161
    v_sub_f32 v15, v15, v161
    v_exp_f32 v0, v0
    v_exp_f32 v1, v1
    v_exp_f32 v2, v2
    v_exp_f32 v3, v3
    v_exp_f32 v4, v4
    v_exp_f32 v5, v5
    v_exp_f32 v6, v6
    v_exp_f32 v7, v7
    v_exp_f32 v8, v8
    v_exp_f32 v9, v9
    v_exp_f32 v10, v10
    v_exp_f32 v11, v11
    v_exp_f32 v12, v12
    v_exp_f32 v13, v13
    v_exp_f32 v14, v14
    v_exp_f32 v15, v15
    s_nop 1
    v_add_f32 v155, v0, v1
    v_add_f32 v155, v155, v2
    v_add_f32 v155, v155, v3
    v_add_f32 v155, v155, v4
    v_add_f32 v155, v155, v5
    v_add_f32 v155, v155, v6
    v_add_f32 v155, v155, v7
    v_add_f32 v155, v155, v8
    v_add_f32 v155, v155, v9
    v_add_f32 v155, v155, v10
    v_add_f32 v155, v155, v11
    v_add_f32 v155, v155, v12
    v_add_f32 v155, v155, v13
    v_add_f32 v155, v155, v14
    v_add_f32 v155, v155, v15
    v_cvt_pk_bf16_f32 v120, v0, v1
    v_cvt_pk_bf16_f32 v121, v2, v3
    v_cvt_pk_bf16_f32 v122, v4, v5
    v_cvt_pk_bf16_f32 v123, v6, v7
    v_cvt_pk_bf16_f32 v124, v8, v9
    v_cvt_pk_bf16_f32 v125, v10, v11
    v_cvt_pk_bf16_f32 v126, v12, v13
    v_cvt_pk_bf16_f32 v127, v14, v15
    v_sub_f32 v32, 0, v161
    v_sub_f32 v33, 0, v161
    v_sub_f32 v34, 0, v161
    v_sub_f32 v35, 0, v161
    v_sub_f32 v36, 0, v161
    v_sub_f32 v37, 0, v161
    v_sub_f32 v38, 0, v161
    v_sub_f32 v39, 0, v161
    v_sub_f32 v40, 0, v161
    v_sub_f32 v41, 0, v161
    v_sub_f32 v42, 0, v161
    v_sub_f32 v43, 0, v161
    v_sub_f32 v44, 0, v161
    v_sub_f32 v45, 0, v161
    v_sub_f32 v46, 0, v161
    v_sub_f32 v47, 0, v161
    s_nop 1
    s_branch L_back_4
L_slow_5:
    s_sub_u32 s38, s27, 12288
    v_mov_b32 v160, v32
    s_nop 7
    buffer_load_dwordx4 v[32:35], v157, s[12:15], s38 offen offset:0
    buffer_load_dwordx4 v[36:39], v157, s[12:15], s38 offen offset:1024
    buffer_load_dwordx4 v[40:43], v157, s[12:15], s38 offen offset:2048
    s_add_u32 s38, s38, 3072
    buffer_load_dwordx4 v[44:47], v157, s[12:15], s38 offen offset:0
    buffer_load_dwordx4 v[128:131], v157, s[12:15], s38 offen offset:1024
    buffer_load_dwordx4 v[132:135], v157, s[12:15], s38 offen offset:2048
    s_waitcnt vmcnt(0)
    v_mfma_f32_32x32x16_bf16 v[16:31], v[32:35], v[96:99], 0
    v_mfma_f32_32x32x16_bf16 v[16:31], v[36:39], v[100:103], v[16:31]
    v_mfma_f32_32x32x16_bf16 v[16:31], v[40:43], v[104:107], v[16:31]
    v_mfma_f32_32x32x16_bf16 v[16:31], v[44:47], v[108:111], v[16:31]
    v_mfma_f32_32x32x16_bf16 v[16:31], v[128:131], v[112:115], v[16:31]
    v_mfma_f32_32x32x16_bf16 v[16:31], v[132:135], v[116:119], v[16:31]
    s_nop 15
    s_nop 15
    v_max3_f32 v161, v16, v17, v18
    v_max3_f32 v161, v161, v19, v20
    v_max3_f32 v161, v161, v21, v22
    v_max3_f32 v161, v161, v23, v24
    v_max3_f32 v161, v161, v25, v26
    v_max3_f32 v161, v161, v27, v28
    v_max3_f32 v161, v161, v29, v30
    v_max_f32 v161, v161, v31
    v_mov_b32 v159, v161
    s_nop 1
    v_permlane32_swap_b32 v161, v159
    s_nop 1
    v_max_f32 v161, v161, v159
    v_max_f32 v161, v161, -v160
    v_sub_f32 v162, -v160, v161
    v_exp_f32 v163, v162
    s_nop 1
    v_mul_f32 v48, v48, v163
    v_mul_f32 v49, v49, v163
    v_mul_f32 v50, v50, v163
    v_mul_f32 v51, v51, v163
    v_mul_f32 v52, v52, v163
    v_mul_f32 v53, v53, v163
    v_mul_f32 v54, v54, v163
    v_mul_f32 v55, v55, v163
    v_mul_f32 v56, v56, v163
    v_mul_f32 v57, v57, v163
    v_mul_f32 v58, v58, v163
    v_mul_f32 v59, v59, v163
    v_mul_f32 v60, v60, v163
    v_mul_f32 v61, v61, v163
    v_mul_f32 v62, v62, v163
    v_mul_f32 v63, v63, v163
    v_mul_f32 v64, v64, v163
    v_mul_f32 v65, v65, v163
    v_mul_f32 v66, v66, v163
    v_mul_f32 v67, v67, v163
    v_mul_f32 v68, v68, v163
    v_mul_f32 v69, v69, v163
    v_mul_f32 v70, v70, v163
    v_mul_f32 v71, v71, v163
    v_mul_f32 v72, v72, v163
    v_mul_f32 v73, v73, v163
    v_mul_f32 v74, v74, v163
    v_mul_f32 v75, v75, v163
    v_mul_f32 v76, v76, v163
    v_mul_f32 v77, v77, v163
    v_mul_f32 v78, v78, v163
    v_mul_f32 v79, v79, v163
    v_mul_f32 v80, v80, v163
    v_mul_f32 v81, v81, v163
    v_mul_f32 v82, v82, v163
    v_mul_f32 v83, v83, v163
    v_mul_f32 v84, v84, v163
    v_mul_f32 v85, v85, v163
    v_mul_f32 v86, v86, v163
    v_mul_f32 v87, v87, v163
    v_mul_f32 v88, v88, v163
    v_mul_f32 v89, v89, v163
    v_mul_f32 v90, v90, v163
    v_mul_f32 v91, v91, v163
    v_mul_f32 v92, v92, v163
    v_mul_f32 v93, v93, v163
    v_mul_f32 v94, v94, v163
    v_mul_f32 v95, v95, v163
    v_mul_f32 v154, v154, v163
    v_add_f32 v0, v0, v162
    v_add_f32 v1, v1, v162
    v_add_f32 v2, v2, v162
    v_add_f32 v3, v3, v162
    v_add_f32 v4, v4, v162
    v_add_f32 v5, v5, v162
    v_add_f32 v6, v6, v162
    v_add_f32 v7, v7, v162
    v_add_f32 v8, v8, v162
    v_add_f32 v9, v9, v162
    v_add_f32 v10, v10, v162
    v_add_f32 v11, v11, v162
    v_add_f32 v12, v12, v162
    v_add_f32 v13, v13, v162
    v_add_f32 v14, v14, v162
    v_add_f32 v15, v15, v162
    v_sub_f32 v16, v16, v161
    v_sub_f32 v17, v17, v161
    v_sub_f32 v18, v18, v161
    v_sub_f32 v19, v19, v161
    v_sub_f32 v20, v20, v161
    v_sub_f32 v21, v21, v161
    v_sub_f32 v22, v22, v161
    v_sub_f32 v23, v23, v161
    v_sub_f32 v24, v24, v161
    v_sub_f32 v25, v25, v161
    v_sub_f32 v26, v26, v161
    v_sub_f32 v27, v27, v161
    v_sub_f32 v28, v28, v161
    v_sub_f32 v29, v29, v161
    v_sub_f32 v30, v30, v161
    v_sub_f32 v31, v31, v161
    v_exp_f32 v16, v16
    v_exp_f32 v17, v17
    v_exp_f32 v18, v18
    v_exp_f32 v19, v19
    v_exp_f32 v20, v20
    v_exp_f32 v21, v21
    v_exp_f32 v22, v22
    v_exp_f32 v23, v23
    v_exp_f32 v24, v24
    v_exp_f32 v25, v25
    v_exp_f32 v26, v26
    v_exp_f32 v27, v27
    v_exp_f32 v28, v28
    v_exp_f32 v29, v29
    v_exp_f32 v30, v30
    v_exp_f32 v31, v31
    s_nop 1
    v_add_f32 v155, v16, v17
    v_add_f32 v155, v155, v18
    v_add_f32 v155, v155, v19
    v_add_f32 v155, v155, v20
    v_add_f32 v155, v155, v21
    v_add_f32 v155, v155, v22
    v_add_f32 v155, v155, v23
    v_add_f32 v155, v155, v24
    v_add_f32 v155, v155, v25
    v_add_f32 v155, v155, v26
    v_add_f32 v155, v155, v27
    v_add_f32 v155, v155, v28
    v_add_f32 v155, v155, v29
    v_add_f32 v155, v155, v30
    v_add_f32 v155, v155, v31
    v_cvt_pk_bf16_f32 v128, v16, v17
    v_cvt_pk_bf16_f32 v129, v18, v19
    v_cvt_pk_bf16_f32 v130, v20, v21
    v_cvt_pk_bf16_f32 v131, v22, v23
    v_cvt_pk_bf16_f32 v132, v24, v25
    v_cvt_pk_bf16_f32 v133, v26, v27
    v_cvt_pk_bf16_f32 v134, v28, v29
    v_cvt_pk_bf16_f32 v135, v30, v31
    v_sub_f32 v32, 0, v161
    v_sub_f32 v33, 0, v161
    v_sub_f32 v34, 0, v161
    v_sub_f32 v35, 0, v161
    v_sub_f32 v36, 0, v161
    v_sub_f32 v37, 0, v161
    v_sub_f32 v38, 0, v161
    v_sub_f32 v39, 0, v161
    v_sub_f32 v40, 0, v161
    v_sub_f32 v41, 0, v161
    v_sub_f32 v42, 0, v161
    v_sub_f32 v43, 0, v161
    v_sub_f32 v44, 0, v161
    v_sub_f32 v45, 0, v161
    v_sub_f32 v46, 0, v161
    v_sub_f32 v47, 0, v161
    s_nop 1
    s_branch L_back_6
L_slow_7:
    s_add_u32 s38, s27, 0
    v_mov_b32 v160, v32
    s_nop 7
    buffer_load_dwordx4 v[32:35], v157, s[12:15], s38 offen offset:0
    buffer_load_dwordx4 v[36:39], v157, s[12:15], s38 offen offset:1024
    buffer_load_dwordx4 v[40:43], v157, s[12:15], s38 offen offset:2048
    s_add_u32 s38, s38, 3072
    buffer_load_dwordx4 v[44:47], v157, s[12:15], s38 offen offset:0
    buffer_load_dwordx4 v[120:123], v157, s[12:15], s38 offen offset:1024
    buffer_load_dwordx4 v[124:127], v157, s[12:15], s38 offen offset:2048
    s_waitcnt vmcnt(0)
    v_mfma_f32_32x32x16_bf16 v[0:15], v[32:35], v[96:99], 0
    v_mfma_f32_32x32x16_bf16 v[0:15], v[36:39], v[100:103], v[0:15]
    v_mfma_f32_32x32x16_bf16 v[0:15], v[40:43], v[104:107], v[0:15]
    v_mfma_f32_32x32x16_bf16 v[0:15], v[44:47], v[108:111], v[0:15]
    v_mfma_f32_32x32x16_bf16 v[0:15], v[120:123], v[112:115], v[0:15]
    v_mfma_f32_32x32x16_bf16 v[0:15], v[124:127], v[116:119], v[0:15]
    s_nop 15
    s_nop 15
    v_max3_f32 v161, v0, v1, v2
    v_max3_f32 v161, v161, v3, v4
    v_max3_f32 v161, v161, v5, v6
    v_max3_f32 v161, v161, v7, v8
    v_max3_f32 v161, v161, v9, v10
    v_max3_f32 v161, v161, v11, v12
    v_max3_f32 v161, v161, v13, v14
    v_max_f32 v161, v161, v15
    v_mov_b32 v159, v161
    s_nop 1
    v_permlane32_swap_b32 v161, v159
    s_nop 1
    v_max_f32 v161, v161, v159
    v_max_f32 v161, v161, -v160
    v_sub_f32 v162, -v160, v161
    v_exp_f32 v163, v162
    s_nop 1
    v_mul_f32 v48, v48, v163
    v_mul_f32 v49, v49, v163
    v_mul_f32 v50, v50, v163
    v_mul_f32 v51, v51, v163
    v_mul_f32 v52, v52, v163
    v_mul_f32 v53, v53, v163
    v_mul_f32 v54, v54, v163
    v_mul_f32 v55, v55, v163
    v_mul_f32 v56, v56, v163
    v_mul_f32 v57, v57, v163
    v_mul_f32 v58, v58, v163
    v_mul_f32 v59, v59, v163
    v_mul_f32 v60, v60, v163
    v_mul_f32 v61, v61, v163
    v_mul_f32 v62, v62, v163
    v_mul_f32 v63, v63, v163
    v_mul_f32 v64, v64, v163
    v_mul_f32 v65, v65, v163
    v_mul_f32 v66, v66, v163
    v_mul_f32 v67, v67, v163
    v_mul_f32 v68, v68, v163
    v_mul_f32 v69, v69, v163
    v_mul_f32 v70, v70, v163
    v_mul_f32 v71, v71, v163
    v_mul_f32 v72, v72, v163
    v_mul_f32 v73, v73, v163
    v_mul_f32 v74, v74, v163
    v_mul_f32 v75, v75, v163
    v_mul_f32 v76, v76, v163
    v_mul_f32 v77, v77, v163
    v_mul_f32 v78, v78, v163
    v_mul_f32 v79, v79, v163
    v_mul_f32 v80, v80, v163
    v_mul_f32 v81, v81, v163
    v_mul_f32 v82, v82, v163
    v_mul_f32 v83, v83, v163
    v_mul_f32 v84, v84, v163
    v_mul_f32 v85, v85, v163
    v_mul_f32 v86, v86, v163
    v_mul_f32 v87, v87, v163
    v_mul_f32 v88, v88, v163
    v_mul_f32 v89, v89, v163
    v_mul_f32 v90, v90, v163
    v_mul_f32 v91, v91, v163
    v_mul_f32 v92, v92, v163
    v_mul_f32 v93, v93, v163
    v_mul_f32 v94, v94, v163
    v_mul_f32 v95, v95, v163
    v_mul_f32 v154, v154, v163
    v_add_f32 v16, v16, v162
    v_add_f32 v17, v17, v162
    v_add_f32 v18, v18, v162
    v_add_f32 v19, v19, v162
    v_add_f32 v20, v20, v162
    v_add_f32 v21, v21, v162
    v_add_f32 v22, v22, v162
    v_add_f32 v23, v23, v162
    v_add_f32 v24, v24, v162
    v_add_f32 v25, v25, v162
    v_add_f32 v26, v26, v162
    v_add_f32 v27, v27, v162
    v_add_f32 v28, v28, v162
    v_add_f32 v29, v29, v162
    v_add_f32 v30, v30, v162
    v_add_f32 v31, v31, v162
    v_sub_f32 v0, v0, v161
    v_sub_f32 v1, v1, v161
    v_sub_f32 v2, v2, v161
    v_sub_f32 v3, v3, v161
    v_sub_f32 v4, v4, v161
    v_sub_f32 v5, v5, v161
    v_sub_f32 v6, v6, v161
    v_sub_f32 v7, v7, v161
    v_sub_f32 v8, v8, v161
    v_sub_f32 v9, v9, v161
    v_sub_f32 v10, v10, v161
    v_sub_f32 v11, v11, v161
    v_sub_f32 v12, v12, v161
    v_sub_f32 v13, v13, v161
    v_sub_f32 v14, v14, v161
    v_sub_f32 v15, v15, v161
    v_exp_f32 v0, v0
    v_exp_f32 v1, v1
    v_exp_f32 v2, v2
    v_exp_f32 v3, v3
    v_exp_f32 v4, v4
    v_exp_f32 v5, v5
    v_exp_f32 v6, v6
    v_exp_f32 v7, v7
    v_exp_f32 v8, v8
    v_exp_f32 v9, v9
    v_exp_f32 v10, v10
    v_exp_f32 v11, v11
    v_exp_f32 v12, v12
    v_exp_f32 v13, v13
    v_exp_f32 v14, v14
    v_exp_f32 v15, v15
    s_nop 1
    v_add_f32 v155, v0, v1
    v_add_f32 v155, v155, v2
    v_add_f32 v155, v155, v3
    v_add_f32 v155, v155, v4
    v_add_f32 v155, v155, v5
    v_add_f32 v155, v155, v6
    v_add_f32 v155, v155, v7
    v_add_f32 v155, v155, v8
    v_add_f32 v155, v155, v9
    v_add_f32 v155, v155, v10
    v_add_f32 v155, v155, v11
    v_add_f32 v155, v155, v12
    v_add_f32 v155, v155, v13
    v_add_f32 v155, v155, v14
    v_add_f32 v155, v155, v15
    v_cvt_pk_bf16_f32 v120, v0, v1
    v_cvt_pk_bf16_f32 v121, v2, v3
    v_cvt_pk_bf16_f32 v122, v4, v5
    v_cvt_pk_bf16_f32 v123, v6, v7
    v_cvt_pk_bf16_f32 v124, v8, v9
    v_cvt_pk_bf16_f32 v125, v10, v11
    v_cvt_pk_bf16_f32 v126, v12, v13
    v_cvt_pk_bf16_f32 v127, v14, v15
    v_sub_f32 v32, 0, v161
    v_sub_f32 v33, 0, v161
    v_sub_f32 v34, 0, v161
    v_sub_f32 v35, 0, v161
    v_sub_f32 v36, 0, v161
    v_sub_f32 v37, 0, v161
    v_sub_f32 v38, 0, v161
    v_sub_f32 v39, 0, v161
    v_sub_f32 v40, 0, v161
    v_sub_f32 v41, 0, v161
    v_sub_f32 v42, 0, v161
    v_sub_f32 v43, 0, v161
    v_sub_f32 v44, 0, v161
    v_sub_f32 v45, 0, v161
    v_sub_f32 v46, 0, v161
    v_sub_f32 v47, 0, v161
    s_nop 1
    s_branch L_back_8
L_slow_9:
    s_add_u32 s38, s27, 12288
    v_mov_b32 v160, v32
    s_nop 7
    buffer_load_dwordx4 v[32:35], v157, s[12:15], s38 offen offset:0
    buffer_load_dwordx4 v[36:39], v157, s[12:15], s38 offen offset:1024
    buffer_load_dwordx4 v[40:43], v157, s[12:15], s38 offen offset:2048
    s_add_u32 s38, s38, 3072
    buffer_load_dwordx4 v[44:47], v157, s[12:15], s38 offen offset:0
    buffer_load_dwordx4 v[128:131], v157, s[12:15], s38 offen offset:1024
    buffer_load_dwordx4 v[132:135], v157, s[12:15], s38 offen offset:2048
    s_waitcnt vmcnt(0)
    v_mfma_f32_32x32x16_bf16 v[16:31], v[32:35], v[96:99], 0
    v_mfma_f32_32x32x16_bf16 v[16:31], v[36:39], v[100:103], v[16:31]
    v_mfma_f32_32x32x16_bf16 v[16:31], v[40:43], v[104:107], v[16:31]
    v_mfma_f32_32x32x16_bf16 v[16:31], v[44:47], v[108:111], v[16:31]
    v_mfma_f32_32x32x16_bf16 v[16:31], v[128:131], v[112:115], v[16:31]
    v_mfma_f32_32x32x16_bf16 v[16:31], v[132:135], v[116:119], v[16:31]
    s_nop 15
    s_nop 15
    v_max3_f32 v161, v16, v17, v18
    v_max3_f32 v161, v161, v19, v20
    v_max3_f32 v161, v161, v21, v22
    v_max3_f32 v161, v161, v23, v24
    v_max3_f32 v161, v161, v25, v26
    v_max3_f32 v161, v161, v27, v28
    v_max3_f32 v161, v161, v29, v30
    v_max_f32 v161, v161, v31
    v_mov_b32 v159, v161
    s_nop 1
    v_permlane32_swap_b32 v161, v159
    s_nop 1
    v_max_f32 v161, v161, v159
    v_max_f32 v161, v161, -v160
    v_sub_f32 v162, -v160, v161
    v_exp_f32 v163, v162
    s_nop 1
    v_mul_f32 v48, v48, v163
    v_mul_f32 v49, v49, v163
    v_mul_f32 v50, v50, v163
    v_mul_f32 v51, v51, v163
    v_mul_f32 v52, v52, v163
    v_mul_f32 v53, v53, v163
    v_mul_f32 v54, v54, v163
    v_mul_f32 v55, v55, v163
    v_mul_f32 v56, v56, v163
    v_mul_f32 v57, v57, v163
    v_mul_f32 v58, v58, v163
    v_mul_f32 v59, v59, v163
    v_mul_f32 v60, v60, v163
    v_mul_f32 v61, v61, v163
    v_mul_f32 v62, v62, v163
    v_mul_f32 v63, v63, v163
    v_mul_f32 v64, v64, v163
    v_mul_f32 v65, v65, v163
    v_mul_f32 v66, v66, v163
    v_mul_f32 v67, v67, v163
    v_mul_f32 v68, v68, v163
    v_mul_f32 v69, v69, v163
    v_mul_f32 v70, v70, v163
    v_mul_f32 v71, v71, v163
    v_mul_f32 v72, v72, v163
    v_mul_f32 v73, v73, v163
    v_mul_f32 v74, v74, v163
    v_mul_f32 v75, v75, v163
    v_mul_f32 v76, v76, v163
    v_mul_f32 v77, v77, v163
    v_mul_f32 v78, v78, v163
    v_mul_f32 v79, v79, v163
    v_mul_f32 v80, v80, v163
    v_mul_f32 v81, v81, v163
    v_mul_f32 v82, v82, v163
    v_mul_f32 v83, v83, v163
    v_mul_f32 v84, v84, v163
    v_mul_f32 v85, v85, v163
    v_mul_f32 v86, v86, v163
    v_mul_f32 v87, v87, v163
    v_mul_f32 v88, v88, v163
    v_mul_f32 v89, v89, v163
    v_mul_f32 v90, v90, v163
    v_mul_f32 v91, v91, v163
    v_mul_f32 v92, v92, v163
    v_mul_f32 v93, v93, v163
    v_mul_f32 v94, v94, v163
    v_mul_f32 v95, v95, v163
    v_mul_f32 v154, v154, v163
    v_add_f32 v0, v0, v162
    v_add_f32 v1, v1, v162
    v_add_f32 v2, v2, v162
    v_add_f32 v3, v3, v162
    v_add_f32 v4, v4, v162
    v_add_f32 v5, v5, v162
    v_add_f32 v6, v6, v162
    v_add_f32 v7, v7, v162
    v_add_f32 v8, v8, v162
    v_add_f32 v9, v9, v162
    v_add_f32 v10, v10, v162
    v_add_f32 v11, v11, v162
    v_add_f32 v12, v12, v162
    v_add_f32 v13, v13, v162
    v_add_f32 v14, v14, v162
    v_add_f32 v15, v15, v162
    v_sub_f32 v16, v16, v161
    v_sub_f32 v17, v17, v161
    v_sub_f32 v18, v18, v161
    v_sub_f32 v19, v19, v161
    v_sub_f32 v20, v20, v161
    v_sub_f32 v21, v21, v161
    v_sub_f32 v22, v22, v161
    v_sub_f32 v23, v23, v161
    v_sub_f32 v24, v24, v161
    v_sub_f32 v25, v25, v161
    v_sub_f32 v26, v26, v161
    v_sub_f32 v27, v27, v161
    v_sub_f32 v28, v28, v161
    v_sub_f32 v29, v29, v161
    v_sub_f32 v30, v30, v161
    v_sub_f32 v31, v31, v161
    v_exp_f32 v16, v16
    v_exp_f32 v17, v17
    v_exp_f32 v18, v18
    v_exp_f32 v19, v19
    v_exp_f32 v20, v20
    v_exp_f32 v21, v21
    v_exp_f32 v22, v22
    v_exp_f32 v23, v23
    v_exp_f32 v24, v24
    v_exp_f32 v25, v25
    v_exp_f32 v26, v26
    v_exp_f32 v27, v27
    v_exp_f32 v28, v28
    v_exp_f32 v29, v29
    v_exp_f32 v30, v30
    v_exp_f32 v31, v31
    s_nop 1
    v_add_f32 v155, v16, v17
    v_add_f32 v155, v155, v18
    v_add_f32 v155, v155, v19
    v_add_f32 v155, v155, v20
    v_add_f32 v155, v155, v21
    v_add_f32 v155, v155, v22
    v_add_f32 v155, v155, v23
    v_add_f32 v155, v155, v24
    v_add_f32 v155, v155, v25
    v_add_f32 v155, v155, v26
    v_add_f32 v155, v155, v27
    v_add_f32 v155, v155, v28
    v_add_f32 v155, v155, v29
    v_add_f32 v155, v155, v30
    v_add_f32 v155, v155, v31
    v_cvt_pk_bf16_f32 v128, v16, v17
    v_cvt_pk_bf16_f32 v129, v18, v19
    v_cvt_pk_bf16_f32 v130, v20, v21
    v_cvt_pk_bf16_f32 v131, v22, v23
    v_cvt_pk_bf16_f32 v132, v24, v25
    v_cvt_pk_bf16_f32 v133, v26, v27
    v_cvt_pk_bf16_f32 v134, v28, v29
    v_cvt_pk_bf16_f32 v135, v30, v31
    v_sub_f32 v32, 0, v161
    v_sub_f32 v33, 0, v161
    v_sub_f32 v34, 0, v161
    v_sub_f32 v35, 0, v161
    v_sub_f32 v36, 0, v161
    v_sub_f32 v37, 0, v161
    v_sub_f32 v38, 0, v161
    v_sub_f32 v39, 0, v161
    v_sub_f32 v40, 0, v161
    v_sub_f32 v41, 0, v161
    v_sub_f32 v42, 0, v161
    v_sub_f32 v43, 0, v161
    v_sub_f32 v44, 0, v161
    v_sub_f32 v45, 0, v161
    v_sub_f32 v46, 0, v161
    v_sub_f32 v47, 0, v161
    s_nop 1
    s_branch L_back_10
L_slow_11:
    s_add_u32 s38, s27, 24576
    v_mov_b32 v160, v32
    s_nop 7
    buffer_load_dwordx4 v[32:35], v157, s[12:15], s38 offen offset:0
    buffer_load_dwordx4 v[36:39], v157, s[12:15], s38 offen offset:1024
    buffer_load_dwordx4 v[40:43], v157, s[12:15], s38 offen offset:2048
    s_add_u32 s38, s38, 3072
    buffer_load_dwordx4 v[44:47], v157, s[12:15], s38 offen offset:0
    buffer_load_dwordx4 v[120:123], v157, s[12:15], s38 offen offset:1024
    buffer_load_dwordx4 v[124:127], v157, s[12:15], s38 offen offset:2048
    s_waitcnt vmcnt(0)
    v_mfma_f32_32x32x16_bf16 v[0:15], v[32:35], v[96:99], 0
    v_mfma_f32_32x32x16_bf16 v[0:15], v[36:39], v[100:103], v[0:15]
    v_mfma_f32_32x32x16_bf16 v[0:15], v[40:43], v[104:107], v[0:15]
    v_mfma_f32_32x32x16_bf16 v[0:15], v[44:47], v[108:111], v[0:15]
    v_mfma_f32_32x32x16_bf16 v[0:15], v[120:123], v[112:115], v[0:15]
    v_mfma_f32_32x32x16_bf16 v[0:15], v[124:127], v[116:119], v[0:15]
    s_nop 15
    s_nop 15
    v_max3_f32 v161, v0, v1, v2
    v_max3_f32 v161, v161, v3, v4
    v_max3_f32 v161, v161, v5, v6
    v_max3_f32 v161, v161, v7, v8
    v_max3_f32 v161, v161, v9, v10
    v_max3_f32 v161, v161, v11, v12
    v_max3_f32 v161, v161, v13, v14
    v_max_f32 v161, v161, v15
    v_mov_b32 v159, v161
    s_nop 1
    v_permlane32_swap_b32 v161, v159
    s_nop 1
    v_max_f32 v161, v161, v159
    v_max_f32 v161, v161, -v160
    v_sub_f32 v162, -v160, v161
    v_exp_f32 v163, v162
    s_nop 1
    v_mul_f32 v48, v48, v163
    v_mul_f32 v49, v49, v163
    v_mul_f32 v50, v50, v163
    v_mul_f32 v51, v51, v163
    v_mul_f32 v52, v52, v163
    v_mul_f32 v53, v53, v163
    v_mul_f32 v54, v54, v163
    v_mul_f32 v55, v55, v163
    v_mul_f32 v56, v56, v163
    v_mul_f32 v57, v57, v163
    v_mul_f32 v58, v58, v163
    v_mul_f32 v59, v59, v163
    v_mul_f32 v60, v60, v163
    v_mul_f32 v61, v61, v163
    v_mul_f32 v62, v62, v163
    v_mul_f32 v63, v63, v163
    v_mul_f32 v64, v64, v163
    v_mul_f32 v65, v65, v163
    v_mul_f32 v66, v66, v163
    v_mul_f32 v67, v67, v163
    v_mul_f32 v68, v68, v163
    v_mul_f32 v69, v69, v163
    v_mul_f32 v70, v70, v163
    v_mul_f32 v71, v71, v163
    v_mul_f32 v72, v72, v163
    v_mul_f32 v73, v73, v163
    v_mul_f32 v74, v74, v163
    v_mul_f32 v75, v75, v163
    v_mul_f32 v76, v76, v163
    v_mul_f32 v77, v77, v163
    v_mul_f32 v78, v78, v163
    v_mul_f32 v79, v79, v163
    v_mul_f32 v80, v80, v163
    v_mul_f32 v81, v81, v163
    v_mul_f32 v82, v82, v163
    v_mul_f32 v83, v83, v163
    v_mul_f32 v84, v84, v163
    v_mul_f32 v85, v85, v163
    v_mul_f32 v86, v86, v163
    v_mul_f32 v87, v87, v163
    v_mul_f32 v88, v88, v163
    v_mul_f32 v89, v89, v163
    v_mul_f32 v90, v90, v163
    v_mul_f32 v91, v91, v163
    v_mul_f32 v92, v92, v163
    v_mul_f32 v93, v93, v163
    v_mul_f32 v94, v94, v163
    v_mul_f32 v95, v95, v163
    v_mul_f32 v154, v154, v163
    v_add_f32 v16, v16, v162
    v_add_f32 v17, v17, v162
    v_add_f32 v18, v18, v162
    v_add_f32 v19, v19, v162
    v_add_f32 v20, v20, v162
    v_add_f32 v21, v21, v162
    v_add_f32 v22, v22, v162
    v_add_f32 v23, v23, v162
    v_add_f32 v24, v24, v162
    v_add_f32 v25, v25, v162
    v_add_f32 v26, v26, v162
    v_add_f32 v27, v27, v162
    v_add_f32 v28, v28, v162
    v_add_f32 v29, v29, v162
    v_add_f32 v30, v30, v162
    v_add_f32 v31, v31, v162
    v_sub_f32 v0, v0, v161
    v_sub_f32 v1, v1, v161
    v_sub_f32 v2, v2, v161
    v_sub_f32 v3, v3, v161
    v_sub_f32 v4, v4, v161
    v_sub_f32 v5, v5, v161
    v_sub_f32 v6, v6, v161
    v_sub_f32 v7, v7, v161
    v_sub_f32 v8, v8, v161
    v_sub_f32 v9, v9, v161
    v_sub_f32 v10, v10, v161
    v_sub_f32 v11, v11, v161
    v_sub_f32 v12, v12, v161
    v_sub_f32 v13, v13, v161
    v_sub_f32 v14, v14, v161
    v_sub_f32 v15, v15, v161
    v_exp_f32 v0, v0
    v_exp_f32 v1, v1
    v_exp_f32 v2, v2
    v_exp_f32 v3, v3
    v_exp_f32 v4, v4
    v_exp_f32 v5, v5
    v_exp_f32 v6, v6
    v_exp_f32 v7, v7
    v_exp_f32 v8, v8
    v_exp_f32 v9, v9
    v_exp_f32 v10, v10
    v_exp_f32 v11, v11
    v_exp_f32 v12, v12
    v_exp_f32 v13, v13
    v_exp_f32 v14, v14
    v_exp_f32 v15, v15
    s_nop 1
    v_add_f32 v155, v0, v1
    v_add_f32 v155, v155, v2
    v_add_f32 v155, v155, v3
    v_add_f32 v155, v155, v4
    v_add_f32 v155, v155, v5
    v_add_f32 v155, v155, v6
    v_add_f32 v155, v155, v7
    v_add_f32 v155, v155, v8
    v_add_f32 v155, v155, v9
    v_add_f32 v155, v155, v10
    v_add_f32 v155, v155, v11
    v_add_f32 v155, v155, v12
    v_add_f32 v155, v155, v13
    v_add_f32 v155, v155, v14
    v_add_f32 v155, v155, v15
    v_cvt_pk_bf16_f32 v120, v0, v1
    v_cvt_pk_bf16_f32 v121, v2, v3
    v_cvt_pk_bf16_f32 v122, v4, v5
    v_cvt_pk_bf16_f32 v123, v6, v7
    v_cvt_pk_bf16_f32 v124, v8, v9
    v_cvt_pk_bf16_f32 v125, v10, v11
    v_cvt_pk_bf16_f32 v126, v12, v13
    v_cvt_pk_bf16_f32 v127, v14, v15
    v_sub_f32 v32, 0, v161
    v_sub_f32 v33, 0, v161
    v_sub_f32 v34, 0, v161
    v_sub_f32 v35, 0, v161
    v_sub_f32 v36, 0, v161
    v_sub_f32 v37, 0, v161
    v_sub_f32 v38, 0, v161
    v_sub_f32 v39, 0, v161
    v_sub_f32 v40, 0, v161
    v_sub_f32 v41, 0, v161
    v_sub_f32 v42, 0, v161
    v_sub_f32 v43, 0, v161
    v_sub_f32 v44, 0, v161
    v_sub_f32 v45, 0, v161
    v_sub_f32 v46, 0, v161
    v_sub_f32 v47, 0, v161
    s_nop 1
    s_branch L_back_12
L_slow_13:
    s_mov_b32 s38, 872448
    v_mov_b32 v160, v32
    s_nop 7
    buffer_load_dwordx4 v[32:35], v157, s[12:15], s38 offen offset:0
    buffer_load_dwordx4 v[36:39], v157, s[12:15], s38 offen offset:1024
    buffer_load_dwordx4 v[40:43], v157, s[12:15], s38 offen offset:2048
    s_add_u32 s38, s38, 3072
    buffer_load_dwordx4 v[44:47], v157, s[12:15], s38 offen offset:0
    buffer_load_dwordx4 v[128:131], v157, s[12:15], s38 offen offset:1024
    buffer_load_dwordx4 v[132:135], v157, s[12:15], s38 offen offset:2048
    s_waitcnt vmcnt(0)
    v_mfma_f32_32x32x16_bf16 v[16:31], v[32:35], v[96:99], 0
    v_mfma_f32_32x32x16_bf16 v[16:31], v[36:39], v[100:103], v[16:31]
    v_mfma_f32_32x32x16_bf16 v[16:31], v[40:43], v[104:107], v[16:31]
    v_mfma_f32_32x32x16_bf16 v[16:31], v[44:47], v[108:111], v[16:31]
    v_mfma_f32_32x32x16_bf16 v[16:31], v[128:131], v[112:115], v[16:31]
    v_mfma_f32_32x32x16_bf16 v[16:31], v[132:135], v[116:119], v[16:31]
    s_nop 15
    s_nop 15
    v_max3_f32 v161, v16, v17, v18
    v_max3_f32 v161, v161, v19, v20
    v_max3_f32 v161, v161, v21, v22
    v_max3_f32 v161, v161, v23, v24
    v_max3_f32 v161, v161, v25, v26
    v_max3_f32 v161, v161, v27, v28
    v_max3_f32 v161, v161, v29, v30
    v_max_f32 v161, v161, v31
    v_mov_b32 v159, v161
    s_nop 1
    v_permlane32_swap_b32 v161, v159
    s_nop 1
    v_max_f32 v161, v161, v159
    v_max_f32 v161, v161, -v160
    v_sub_f32 v162, -v160, v161
    v_exp_f32 v163, v162
    s_nop 1
    v_mul_f32 v48, v48, v163
    v_mul_f32 v49, v49, v163
    v_mul_f32 v50, v50, v163
    v_mul_f32 v51, v51, v163
    v_mul_f32 v52, v52, v163
    v_mul_f32 v53, v53, v163
    v_mul_f32 v54, v54, v163
    v_mul_f32 v55, v55, v163
    v_mul_f32 v56, v56, v163
    v_mul_f32 v57, v57, v163
    v_mul_f32 v58, v58, v163
    v_mul_f32 v59, v59, v163
    v_mul_f32 v60, v60, v163
    v_mul_f32 v61, v61, v163
    v_mul_f32 v62, v62, v163
    v_mul_f32 v63, v63, v163
    v_mul_f32 v64, v64, v163
    v_mul_f32 v65, v65, v163
    v_mul_f32 v66, v66, v163
    v_mul_f32 v67, v67, v163
    v_mul_f32 v68, v68, v163
    v_mul_f32 v69, v69, v163
    v_mul_f32 v70, v70, v163
    v_mul_f32 v71, v71, v163
    v_mul_f32 v72, v72, v163
    v_mul_f32 v73, v73, v163
    v_mul_f32 v74, v74, v163
    v_mul_f32 v75, v75, v163
    v_mul_f32 v76, v76, v163
    v_mul_f32 v77, v77, v163
    v_mul_f32 v78, v78, v163
    v_mul_f32 v79, v79, v163
    v_mul_f32 v80, v80, v163
    v_mul_f32 v81, v81, v163
    v_mul_f32 v82, v82, v163
    v_mul_f32 v83, v83, v163
    v_mul_f32 v84, v84, v163
    v_mul_f32 v85, v85, v163
    v_mul_f32 v86, v86, v163
    v_mul_f32 v87, v87, v163
    v_mul_f32 v88, v88, v163
    v_mul_f32 v89, v89, v163
    v_mul_f32 v90, v90, v163
    v_mul_f32 v91, v91, v163
    v_mul_f32 v92, v92, v163
    v_mul_f32 v93, v93, v163
    v_mul_f32 v94, v94, v163
    v_mul_f32 v95, v95, v163
    v_mul_f32 v154, v154, v163
    v_add_f32 v0, v0, v162
    v_add_f32 v1, v1, v162
    v_add_f32 v2, v2, v162
    v_add_f32 v3, v3, v162
    v_add_f32 v4, v4, v162
    v_add_f32 v5, v5, v162
    v_add_f32 v6, v6, v162
    v_add_f32 v7, v7, v162
    v_add_f32 v8, v8, v162
    v_add_f32 v9, v9, v162
    v_add_f32 v10, v10, v162
    v_add_f32 v11, v11, v162
    v_add_f32 v12, v12, v162
    v_add_f32 v13, v13, v162
    v_add_f32 v14, v14, v162
    v_add_f32 v15, v15, v162
    v_sub_f32 v16, v16, v161
    v_sub_f32 v17, v17, v161
    v_sub_f32 v18, v18, v161
    v_sub_f32 v19, v19, v161
    v_sub_f32 v20, v20, v161
    v_sub_f32 v21, v21, v161
    v_sub_f32 v22, v22, v161
    v_sub_f32 v23, v23, v161
    v_sub_f32 v24, v24, v161
    v_sub_f32 v25, v25, v161
    v_sub_f32 v26, v26, v161
    v_sub_f32 v27, v27, v161
    v_sub_f32 v28, v28, v161
    v_sub_f32 v29, v29, v161
    v_sub_f32 v30, v30, v161
    v_sub_f32 v31, v31, v161
    v_exp_f32 v16, v16
    v_exp_f32 v17, v17
    v_exp_f32 v18, v18
    v_exp_f32 v19, v19
    v_exp_f32 v20, v20
    v_exp_f32 v21, v21
    v_exp_f32 v22, v22
    v_exp_f32 v23, v23
    v_exp_f32 v24, v24
    v_exp_f32 v25, v25
    v_exp_f32 v26, v26
    v_exp_f32 v27, v27
    v_exp_f32 v28, v28
    v_exp_f32 v29, v29
    v_exp_f32 v30, v30
    v_exp_f32 v31, v31
    s_nop 1
    v_add_f32 v155, v16, v17
    v_add_f32 v155, v155, v18
    v_add_f32 v155, v155, v19
    v_add_f32 v155, v155, v20
    v_add_f32 v155, v155, v21
    v_add_f32 v155, v155, v22
    v_add_f32 v155, v155, v23
    v_add_f32 v155, v155, v24
    v_add_f32 v155, v155, v25
    v_add_f32 v155, v155, v26
    v_add_f32 v155, v155, v27
    v_add_f32 v155, v155, v28
    v_add_f32 v155, v155, v29
    v_add_f32 v155, v155, v30
    v_add_f32 v155, v155, v31
    v_cvt_pk_bf16_f32 v128, v16, v17
    v_cvt_pk_bf16_f32 v129, v18, v19
    v_cvt_pk_bf16_f32 v130, v20, v21
    v_cvt_pk_bf16_f32 v131, v22, v23
    v_cvt_pk_bf16_f32 v132, v24, v25
    v_cvt_pk_bf16_f32 v133, v26, v27
    v_cvt_pk_bf16_f32 v134, v28, v29
    v_cvt_pk_bf16_f32 v135, v30, v31
    v_sub_f32 v32, 0, v161
    v_sub_f32 v33, 0, v161
    v_sub_f32 v34, 0, v161
    v_sub_f32 v35, 0, v161
    v_sub_f32 v36, 0, v161
    v_sub_f32 v37, 0, v161
    v_sub_f32 v38, 0, v161
    v_sub_f32 v39, 0, v161
    v_sub_f32 v40, 0, v161
    v_sub_f32 v41, 0, v161
    v_sub_f32 v42, 0, v161
    v_sub_f32 v43, 0, v161
    v_sub_f32 v44, 0, v161
    v_sub_f32 v45, 0, v161
    v_sub_f32 v46, 0, v161
    v_sub_f32 v47, 0, v161
    s_nop 1
    s_branch L_back_14
L_slow_15:
    s_sub_u32 s38, s27, 24576
    v_mov_b32 v160, v32
    s_nop 7
    buffer_load_dwordx4 v[32:35], v157, s[12:15], s38 offen offset:0
    buffer_load_dwordx4 v[36:39], v157, s[12:15], s38 offen offset:1024
    buffer_load_dwordx4 v[40:43], v157, s[12:15], s38 offen offset:2048
    s_add_u32 s38, s38, 3072
    buffer_load_dwordx4 v[44:47], v157, s[12:15], s38 offen offset:0
    buffer_load_dwordx4 v[128:131], v157, s[12:15], s38 offen offset:1024
    buffer_load_dwordx4 v[132:135], v157, s[12:15], s38 offen offset:2048
    s_waitcnt vmcnt(0)
    v_mfma_f32_32x32x16_bf16 v[16:31], v[32:35], v[96:99], 0
    v_mfma_f32_32x32x16_bf16 v[16:31], v[36:39], v[100:103], v[16:31]
    v_mfma_f32_32x32x16_bf16 v[16:31], v[40:43], v[104:107], v[16:31]
    v_mfma_f32_32x32x16_bf16 v[16:31], v[44:47], v[108:111], v[16:31]
    v_mfma_f32_32x32x16_bf16 v[16:31], v[128:131], v[112:115], v[16:31]
    v_mfma_f32_32x32x16_bf16 v[16:31], v[132:135], v[116:119], v[16:31]
    s_nop 15
    s_nop 15
    v_max3_f32 v161, v16, v17, v18
    v_max3_f32 v161, v161, v19, v20
    v_max3_f32 v161, v161, v21, v22
    v_max3_f32 v161, v161, v23, v24
    v_max3_f32 v161, v161, v25, v26
    v_max3_f32 v161, v161, v27, v28
    v_max3_f32 v161, v161, v29, v30
    v_max_f32 v161, v161, v31
    v_mov_b32 v159, v161
    s_nop 1
    v_permlane32_swap_b32 v161, v159
    s_nop 1
    v_max_f32 v161, v161, v159
    v_max_f32 v161, v161, -v160
    v_sub_f32 v162, -v160, v161
    v_exp_f32 v163, v162
    s_nop 1
    v_mul_f32 v48, v48, v163
    v_mul_f32 v49, v49, v163
    v_mul_f32 v50, v50, v163
    v_mul_f32 v51, v51, v163
    v_mul_f32 v52, v52, v163
    v_mul_f32 v53, v53, v163
    v_mul_f32 v54, v54, v163
    v_mul_f32 v55, v55, v163
    v_mul_f32 v56, v56, v163
    v_mul_f32 v57, v57, v163
    v_mul_f32 v58, v58, v163
    v_mul_f32 v59, v59, v163
    v_mul_f32 v60, v60, v163
    v_mul_f32 v61, v61, v163
    v_mul_f32 v62, v62, v163
    v_mul_f32 v63, v63, v163
    v_mul_f32 v64, v64, v163
    v_mul_f32 v65, v65, v163
    v_mul_f32 v66, v66, v163
    v_mul_f32 v67, v67, v163
    v_mul_f32 v68, v68, v163
    v_mul_f32 v69, v69, v163
    v_mul_f32 v70, v70, v163
    v_mul_f32 v71, v71, v163
    v_mul_f32 v72, v72, v163
    v_mul_f32 v73, v73, v163
    v_mul_f32 v74, v74, v163
    v_mul_f32 v75, v75, v163
    v_mul_f32 v76, v76, v163
    v_mul_f32 v77, v77, v163
    v_mul_f32 v78, v78, v163
    v_mul_f32 v79, v79, v163
    v_mul_f32 v80, v80, v163
    v_mul_f32 v81, v81, v163
    v_mul_f32 v82, v82, v163
    v_mul_f32 v83, v83, v163
    v_mul_f32 v84, v84, v163
    v_mul_f32 v85, v85, v163
    v_mul_f32 v86, v86, v163
    v_mul_f32 v87, v87, v163
    v_mul_f32 v88, v88, v163
    v_mul_f32 v89, v89, v163
    v_mul_f32 v90, v90, v163
    v_mul_f32 v91, v91, v163
    v_mul_f32 v92, v92, v163
    v_mul_f32 v93, v93, v163
    v_mul_f32 v94, v94, v163
    v_mul_f32 v95, v95, v163
    v_mul_f32 v154, v154, v163
    v_add_f32 v0, v0, v162
    v_add_f32 v1, v1, v162
    v_add_f32 v2, v2, v162
    v_add_f32 v3, v3, v162
    v_add_f32 v4, v4, v162
    v_add_f32 v5, v5, v162
    v_add_f32 v6, v6, v162
    v_add_f32 v7, v7, v162
    v_add_f32 v8, v8, v162
    v_add_f32 v9, v9, v162
    v_add_f32 v10, v10, v162
    v_add_f32 v11, v11, v162
    v_add_f32 v12, v12, v162
    v_add_f32 v13, v13, v162
    v_add_f32 v14, v14, v162
    v_add_f32 v15, v15, v162
    v_sub_f32 v16, v16, v161
    v_sub_f32 v17, v17, v161
    v_sub_f32 v18, v18, v161
    v_sub_f32 v19, v19, v161
    v_sub_f32 v20, v20, v161
    v_sub_f32 v21, v21, v161
    v_sub_f32 v22, v22, v161
    v_sub_f32 v23, v23, v161
    v_sub_f32 v24, v24, v161
    v_sub_f32 v25, v25, v161
    v_sub_f32 v26, v26, v161
    v_sub_f32 v27, v27, v161
    v_sub_f32 v28, v28, v161
    v_sub_f32 v29, v29, v161
    v_sub_f32 v30, v30, v161
    v_sub_f32 v31, v31, v161
    v_exp_f32 v16, v16
    v_exp_f32 v17, v17
    v_exp_f32 v18, v18
    v_exp_f32 v19, v19
    v_exp_f32 v20, v20
    v_exp_f32 v21, v21
    v_exp_f32 v22, v22
    v_exp_f32 v23, v23
    v_exp_f32 v24, v24
    v_exp_f32 v25, v25
    v_exp_f32 v26, v26
    v_exp_f32 v27, v27
    v_exp_f32 v28, v28
    v_exp_f32 v29, v29
    v_exp_f32 v30, v30
    v_exp_f32 v31, v31
    s_nop 1
    v_add_f32 v155, v16, v17
    v_add_f32 v155, v155, v18
    v_add_f32 v155, v155, v19
    v_add_f32 v155, v155, v20
    v_add_f32 v155, v155, v21
    v_add_f32 v155, v155, v22
    v_add_f32 v155, v155, v23
    v_add_f32 v155, v155, v24
    v_add_f32 v155, v155, v25
    v_add_f32 v155, v155, v26
    v_add_f32 v155, v155, v27
    v_add_f32 v155, v155, v28
    v_add_f32 v155, v155, v29
    v_add_f32 v155, v155, v30
    v_add_f32 v155, v155, v31
    v_cvt_pk_bf16_f32 v128, v16, v17
    v_cvt_pk_bf16_f32 v129, v18, v19
    v_cvt_pk_bf16_f32 v130, v20, v21
    v_cvt_pk_bf16_f32 v131, v22, v23
    v_cvt_pk_bf16_f32 v132, v24, v25
    v_cvt_pk_bf16_f32 v133, v26, v27
    v_cvt_pk_bf16_f32 v134, v28, v29
    v_cvt_pk_bf16_f32 v135, v30, v31
    v_sub_f32 v32, 0, v161
    v_sub_f32 v33, 0, v161
    v_sub_f32 v34, 0, v161
    v_sub_f32 v35, 0, v161
    v_sub_f32 v36, 0, v161
    v_sub_f32 v37, 0, v161
    v_sub_f32 v38, 0, v161
    v_sub_f32 v39, 0, v161
    v_sub_f32 v40, 0, v161
    v_sub_f32 v41, 0, v161
    v_sub_f32 v42, 0, v161
    v_sub_f32 v43, 0, v161
    v_sub_f32 v44, 0, v161
    v_sub_f32 v45, 0, v161
    v_sub_f32 v46, 0, v161
    v_sub_f32 v47, 0, v161
    s_nop 1
    s_branch L_back_16
L_slow_17:
    s_mov_b32 s38, s27
    v_mov_b32 v160, v32
    s_nop 7
    buffer_load_dwordx4 v[32:35], v157, s[12:15], s38 offen offset:0
    buffer_load_dwordx4 v[36:39], v157, s[12:15], s38 offen offset:1024
    buffer_load_dwordx4 v[40:43], v157, s[12:15], s38 offen offset:2048
    s_add_u32 s38, s38, 3072
    buffer_load_dwordx4 v[44:47], v157, s[12:15], s38 offen offset:0
    buffer_load_dwordx4 v[120:123], v157, s[12:15], s38 offen offset:1024
    buffer_load_dwordx4 v[124:127], v157, s[12:15], s38 offen offset:2048
    s_waitcnt vmcnt(0)
    v_mfma_f32_32x32x16_bf16 v[0:15], v[32:35], v[96:99], 0
    v_mfma_f32_32x32x16_bf16 v[0:15], v[36:39], v[100:103], v[0:15]
    v_mfma_f32_32x32x16_bf16 v[0:15], v[40:43], v[104:107], v[0:15]
    v_mfma_f32_32x32x16_bf16 v[0:15], v[44:47], v[108:111], v[0:15]
    v_mfma_f32_32x32x16_bf16 v[0:15], v[120:123], v[112:115], v[0:15]
    v_mfma_f32_32x32x16_bf16 v[0:15], v[124:127], v[116:119], v[0:15]
    s_nop 15
    s_nop 15
    v_max3_f32 v161, v0, v1, v2
    v_max3_f32 v161, v161, v3, v4
    v_max3_f32 v161, v161, v5, v6
    v_max3_f32 v161, v161, v7, v8
    v_max3_f32 v161, v161, v9, v10
    v_max3_f32 v161, v161, v11, v12
    v_max3_f32 v161, v161, v13, v14
    v_max_f32 v161, v161, v15
    v_mov_b32 v159, v161
    s_nop 1
    v_permlane32_swap_b32 v161, v159
    s_nop 1
    v_max_f32 v161, v161, v159
    v_max_f32 v161, v161, -v160
    v_sub_f32 v162, -v160, v161
    v_exp_f32 v163, v162
    s_nop 1
    v_mul_f32 v48, v48, v163
    v_mul_f32 v49, v49, v163
    v_mul_f32 v50, v50, v163
    v_mul_f32 v51, v51, v163
    v_mul_f32 v52, v52, v163
    v_mul_f32 v53, v53, v163
    v_mul_f32 v54, v54, v163
    v_mul_f32 v55, v55, v163
    v_mul_f32 v56, v56, v163
    v_mul_f32 v57, v57, v163
    v_mul_f32 v58, v58, v163
    v_mul_f32 v59, v59, v163
    v_mul_f32 v60, v60, v163
    v_mul_f32 v61, v61, v163
    v_mul_f32 v62, v62, v163
    v_mul_f32 v63, v63, v163
    v_mul_f32 v64, v64, v163
    v_mul_f32 v65, v65, v163
    v_mul_f32 v66, v66, v163
    v_mul_f32 v67, v67, v163
    v_mul_f32 v68, v68, v163
    v_mul_f32 v69, v69, v163
    v_mul_f32 v70, v70, v163
    v_mul_f32 v71, v71, v163
    v_mul_f32 v72, v72, v163
    v_mul_f32 v73, v73, v163
    v_mul_f32 v74, v74, v163
    v_mul_f32 v75, v75, v163
    v_mul_f32 v76, v76, v163
    v_mul_f32 v77, v77, v163
    v_mul_f32 v78, v78, v163
    v_mul_f32 v79, v79, v163
    v_mul_f32 v80, v80, v163
    v_mul_f32 v81, v81, v163
    v_mul_f32 v82, v82, v163
    v_mul_f32 v83, v83, v163
    v_mul_f32 v84, v84, v163
    v_mul_f32 v85, v85, v163
    v_mul_f32 v86, v86, v163
    v_mul_f32 v87, v87, v163
    v_mul_f32 v88, v88, v163
    v_mul_f32 v89, v89, v163
    v_mul_f32 v90, v90, v163
    v_mul_f32 v91, v91, v163
    v_mul_f32 v92, v92, v163
    v_mul_f32 v93, v93, v163
    v_mul_f32 v94, v94, v163
    v_mul_f32 v95, v95, v163
    v_mul_f32 v154, v154, v163
    v_add_f32 v16, v16, v162
    v_add_f32 v17, v17, v162
    v_add_f32 v18, v18, v162
    v_add_f32 v19, v19, v162
    v_add_f32 v20, v20, v162
    v_add_f32 v21, v21, v162
    v_add_f32 v22, v22, v162
    v_add_f32 v23, v23, v162
    v_add_f32 v24, v24, v162
    v_add_f32 v25, v25, v162
    v_add_f32 v26, v26, v162
    v_add_f32 v27, v27, v162
    v_add_f32 v28, v28, v162
    v_add_f32 v29, v29, v162
    v_add_f32 v30, v30, v162
    v_add_f32 v31, v31, v162
    v_sub_f32 v0, v0, v161
    v_sub_f32 v1, v1, v161
    v_sub_f32 v2, v2, v161
    v_sub_f32 v3, v3, v161
    v_sub_f32 v4, v4, v161
    v_sub_f32 v5, v5, v161
    v_sub_f32 v6, v6, v161
    v_sub_f32 v7, v7, v161
    v_sub_f32 v8, v8, v161
    v_sub_f32 v9, v9, v161
    v_sub_f32 v10, v10, v161
    v_sub_f32 v11, v11, v161
    v_sub_f32 v12, v12, v161
    v_sub_f32 v13, v13, v161
    v_sub_f32 v14, v14, v161
    v_sub_f32 v15, v15, v161
    v_exp_f32 v0, v0
    v_exp_f32 v1, v1
    v_exp_f32 v2, v2
    v_exp_f32 v3, v3
    v_exp_f32 v4, v4
    v_exp_f32 v5, v5
    v_exp_f32 v6, v6
    v_exp_f32 v7, v7
    v_exp_f32 v8, v8
    v_exp_f32 v9, v9
    v_exp_f32 v10, v10
    v_exp_f32 v11, v11
    v_exp_f32 v12, v12
    v_exp_f32 v13, v13
    v_exp_f32 v14, v14
    v_exp_f32 v15, v15
    s_nop 1
    v_add_f32 v155, v0, v1
    v_add_f32 v155, v155, v2
    v_add_f32 v155, v155, v3
    v_add_f32 v155, v155, v4
    v_add_f32 v155, v155, v5
    v_add_f32 v155, v155, v6
    v_add_f32 v155, v155, v7
    v_add_f32 v155, v155, v8
    v_add_f32 v155, v155, v9
    v_add_f32 v155, v155, v10
    v_add_f32 v155, v155, v11
    v_add_f32 v155, v155, v12
    v_add_f32 v155, v155, v13
    v_add_f32 v155, v155, v14
    v_add_f32 v155, v155, v15
    v_cvt_pk_bf16_f32 v120, v0, v1
    v_cvt_pk_bf16_f32 v121, v2, v3
    v_cvt_pk_bf16_f32 v122, v4, v5
    v_cvt_pk_bf16_f32 v123, v6, v7
    v_cvt_pk_bf16_f32 v124, v8, v9
    v_cvt_pk_bf16_f32 v125, v10, v11
    v_cvt_pk_bf16_f32 v126, v12, v13
    v_cvt_pk_bf16_f32 v127, v14, v15
    v_sub_f32 v32, 0, v161
    v_sub_f32 v33, 0, v161
    v_sub_f32 v34, 0, v161
    v_sub_f32 v35, 0, v161
    v_sub_f32 v36, 0, v161
    v_sub_f32 v37, 0, v161
    v_sub_f32 v38, 0, v161
    v_sub_f32 v39, 0, v161
    v_sub_f32 v40, 0, v161
    v_sub_f32 v41, 0, v161
    v_sub_f32 v42, 0, v161
    v_sub_f32 v43, 0, v161
    v_sub_f32 v44, 0, v161
    v_sub_f32 v45, 0, v161
    v_sub_f32 v46, 0, v161
    v_sub_f32 v47, 0, v161
    s_nop 1
    s_branch L_back_18
L_slow_20:
    s_mul_i32 s38, s17, 12288
    s_add_u32 s38, s38, 860160
    v_mov_b32 v160, v32
    s_nop 7
    buffer_load_dwordx4 v[32:35], v157, s[12:15], s38 offen offset:0
    buffer_load_dwordx4 v[36:39], v157, s[12:15], s38 offen offset:1024
    buffer_load_dwordx4 v[40:43], v157, s[12:15], s38 offen offset:2048
    s_add_u32 s38, s38, 3072
    buffer_load_dwordx4 v[44:47], v157, s[12:15], s38 offen offset:0
    buffer_load_dwordx4 v[128:131], v157, s[12:15], s38 offen offset:1024
    buffer_load_dwordx4 v[132:135], v157, s[12:15], s38 offen offset:2048
    s_waitcnt vmcnt(0)
    v_mfma_f32_32x32x16_bf16 v[16:31], v[32:35], v[96:99], 0
    v_mfma_f32_32x32x16_bf16 v[16:31], v[36:39], v[100:103], v[16:31]
    v_mfma_f32_32x32x16_bf16 v[16:31], v[40:43], v[104:107], v[16:31]
    v_mfma_f32_32x32x16_bf16 v[16:31], v[44:47], v[108:111], v[16:31]
    v_mfma_f32_32x32x16_bf16 v[16:31], v[128:131], v[112:115], v[16:31]
    v_mfma_f32_32x32x16_bf16 v[16:31], v[132:135], v[116:119], v[16:31]
    s_nop 15
    s_nop 15
    v_max3_f32 v161, v16, v17, v18
    v_max3_f32 v161, v161, v19, v20
    v_max3_f32 v161, v161, v21, v22
    v_max3_f32 v161, v161, v23, v24
    v_max3_f32 v161, v161, v25, v26
    v_max3_f32 v161, v161, v27, v28
    v_max3_f32 v161, v161, v29, v30
    v_max_f32 v161, v161, v31
    v_mov_b32 v159, v161
    s_nop 1
    v_permlane32_swap_b32 v161, v159
    s_nop 1
    v_max_f32 v161, v161, v159
    v_max_f32 v161, v161, -v160
    v_sub_f32 v162, -v160, v161
    v_exp_f32 v163, v162
    s_nop 1
    v_mul_f32 v48, v48, v163
    v_mul_f32 v49, v49, v163
    v_mul_f32 v50, v50, v163
    v_mul_f32 v51, v51, v163
    v_mul_f32 v52, v52, v163
    v_mul_f32 v53, v53, v163
    v_mul_f32 v54, v54, v163
    v_mul_f32 v55, v55, v163
    v_mul_f32 v56, v56, v163
    v_mul_f32 v57, v57, v163
    v_mul_f32 v58, v58, v163
    v_mul_f32 v59, v59, v163
    v_mul_f32 v60, v60, v163
    v_mul_f32 v61, v61, v163
    v_mul_f32 v62, v62, v163
    v_mul_f32 v63, v63, v163
    v_mul_f32 v64, v64, v163
    v_mul_f32 v65, v65, v163
    v_mul_f32 v66, v66, v163
    v_mul_f32 v67, v67, v163
    v_mul_f32 v68, v68, v163
    v_mul_f32 v69, v69, v163
    v_mul_f32 v70, v70, v163
    v_mul_f32 v71, v71, v163
    v_mul_f32 v72, v72, v163
    v_mul_f32 v73, v73, v163
    v_mul_f32 v74, v74, v163
    v_mul_f32 v75, v75, v163
    v_mul_f32 v76, v76, v163
    v_mul_f32 v77, v77, v163
    v_mul_f32 v78, v78, v163
    v_mul_f32 v79, v79, v163
    v_mul_f32 v80, v80, v163
    v_mul_f32 v81, v81, v163
    v_mul_f32 v82, v82, v163
    v_mul_f32 v83, v83, v163
    v_mul_f32 v84, v84, v163
    v_mul_f32 v85, v85, v163
    v_mul_f32 v86, v86, v163
    v_mul_f32 v87, v87, v163
    v_mul_f32 v88, v88, v163
    v_mul_f32 v89, v89, v163
    v_mul_f32 v90, v90, v163
    v_mul_f32 v91, v91, v163
    v_mul_f32 v92, v92, v163
    v_mul_f32 v93, v93, v163
    v_mul_f32 v94, v94, v163
    v_mul_f32 v95, v95, v163
    v_mul_f32 v154, v154, v163
    v_add_f32 v0, v0, v162
    v_add_f32 v1, v1, v162
    v_add_f32 v2, v2, v162
    v_add_f32 v3, v3, v162
    v_add_f32 v4, v4, v162
    v_add_f32 v5, v5, v162
    v_add_f32 v6, v6, v162
    v_add_f32 v7, v7, v162
    v_add_f32 v8, v8, v162
    v_add_f32 v9, v9, v162
    v_add_f32 v10, v10, v162
    v_add_f32 v11, v11, v162
    v_add_f32 v12, v12, v162
    v_add_f32 v13, v13, v162
    v_add_f32 v14, v14, v162
    v_add_f32 v15, v15, v162
    v_sub_f32 v16, v16, v161
    v_sub_f32 v17, v17, v161
    v_sub_f32 v18, v18, v161
    v_sub_f32 v19, v19, v161
    v_sub_f32 v20, v20, v161
    v_sub_f32 v21, v21, v161
    v_sub_f32 v22, v22, v161
    v_sub_f32 v23, v23, v161
    v_sub_f32 v24, v24, v161
    v_sub_f32 v25, v25, v161
    v_sub_f32 v26, v26, v161
    v_sub_f32 v27, v27, v161
    v_sub_f32 v28, v28, v161
    v_sub_f32 v29, v29, v161
    v_sub_f32 v30, v30, v161
    v_sub_f32 v31, v31, v161
    v_exp_f32 v16, v16
    v_exp_f32 v17, v17
    v_exp_f32 v18, v18
    v_exp_f32 v19, v19
    v_exp_f32 v20, v20
    v_exp_f32 v21, v21
    v_exp_f32 v22, v22
    v_exp_f32 v23, v23
    v_exp_f32 v24, v24
    v_exp_f32 v25, v25
    v_exp_f32 v26, v26
    v_exp_f32 v27, v27
    v_exp_f32 v28, v28
    v_exp_f32 v29, v29
    v_exp_f32 v30, v30
    v_exp_f32 v31, v31
    s_nop 1
    v_add_f32 v155, v16, v17
    v_add_f32 v155, v155, v18
    v_add_f32 v155, v155, v19
    v_add_f32 v155, v155, v20
    v_add_f32 v155, v155, v21
    v_add_f32 v155, v155, v22
    v_add_f32 v155, v155, v23
    v_add_f32 v155, v155, v24
    v_add_f32 v155, v155, v25
    v_add_f32 v155, v155, v26
    v_add_f32 v155, v155, v27
    v_add_f32 v155, v155, v28
    v_add_f32 v155, v155, v29
    v_add_f32 v155, v155, v30
    v_add_f32 v155, v155, v31
    v_cvt_pk_bf16_f32 v128, v16, v17
    v_cvt_pk_bf16_f32 v129, v18, v19
    v_cvt_pk_bf16_f32 v130, v20, v21
    v_cvt_pk_bf16_f32 v131, v22, v23
    v_cvt_pk_bf16_f32 v132, v24, v25
    v_cvt_pk_bf16_f32 v133, v26, v27
    v_cvt_pk_bf16_f32 v134, v28, v29
    v_cvt_pk_bf16_f32 v135, v30, v31
    v_sub_f32 v32, 0, v161
    v_sub_f32 v33, 0, v161
    v_sub_f32 v34, 0, v161
    v_sub_f32 v35, 0, v161
    v_sub_f32 v36, 0, v161
    v_sub_f32 v37, 0, v161
    v_sub_f32 v38, 0, v161
    v_sub_f32 v39, 0, v161
    v_sub_f32 v40, 0, v161
    v_sub_f32 v41, 0, v161
    v_sub_f32 v42, 0, v161
    v_sub_f32 v43, 0, v161
    v_sub_f32 v44, 0, v161
    v_sub_f32 v45, 0, v161
    v_sub_f32 v46, 0, v161
    v_sub_f32 v47, 0, v161
    s_nop 1
    s_branch L_back_21
.section .rodata,"a"
.p2align 6
.amdhsa_kernel attn_main_kernel
  .amdhsa_next_free_vgpr 168
  .amdhsa_next_free_sgpr 72
  .amdhsa_accum_offset 168
  .amdhsa_group_segment_fixed_size 0
  .amdhsa_kernarg_size 56
  .amdhsa_user_sgpr_count 2
  .amdhsa_user_sgpr_kernarg_segment_ptr 1
  .amdhsa_system_sgpr_workgroup_id_x 1
.end_amdhsa_kernel
```
